```python
import torch

def _softmax(x, axis=-1):
    return torch.softmax(x, dim=axis)
def _gelu(x):
    return torch.nn.functional.gelu(x, approximate="tanh")
def _silu(x):
    return torch.nn.functional.silu(x)
def _sigmoid(x):
    return torch.sigmoid(x)
def _layernorm(x, axis=-1, eps=1e-5):
    m = x.mean(dim=axis, keepdim=True)
    v = x.var(dim=axis, keepdim=True, unbiased=False)
    return (x - m) / torch.sqrt(v + eps)
def _scatter_add(tgt, idx, src, axis=0):
    return tgt.clone().index_add_(axis, idx, src)
def _segment_sum(src, seg, n):
    out = torch.zeros((n,) + src.shape[1:], dtype=src.dtype)
    return out.index_add_(0, seg, src)
def _pad(x, pw):
    flat = tuple(v for pair in reversed(pw) for v in pair)
    return torch.nn.functional.pad(x, flat)

kernel_name = 'sequential_preLN__sliding_local_dilated__glu_gated_reglu__prompt'

def setup_inputs():

    _w = (lambda a: (lambda t: t.to(torch.bfloat16) if t.is_floating_point() else t)(torch.as_tensor(a)))
    def _A_setup():
        B, S, D = 1, 2048, 512
        return {
            "x": _w((lambda *s: torch.randn(*s, dtype=torch.bfloat16) * 0.05)(B, S, D)),
            "wqkv": _w((lambda *s: torch.randn(*s, dtype=torch.bfloat16) * 0.05)(D, 3 * D)),
            "wo": _w((lambda *s: torch.randn(*s, dtype=torch.bfloat16) * 0.05)(D, D)),
        }
    _A_in = _A_setup()

    def _B_setup():
        B, S, D, F = 1, 2048, 512, 1376
        return {
            "x": _w((lambda *s: torch.randn(*s, dtype=torch.bfloat16) * 0.05)(B, S, D)),
            "W_gate": _w((lambda *s: torch.randn(*s, dtype=torch.bfloat16) * 0.8)(D, F) * (2.0 / D) ** 0.5),
            "W_up": _w((lambda *s: torch.randn(*s, dtype=torch.bfloat16) * 0.8)(D, F) * (2.0 / D) ** 0.5),
            "W_down": _w((lambda *s: torch.randn(*s, dtype=torch.bfloat16) * 0.8)(F, D) * (1.0 / F) ** 0.5),
        }
    _B_in = _B_setup()

    return {
        "A_x": _A_in["x"],
        "A_wqkv": _A_in["wqkv"],
        "A_wo": _A_in["wo"],
        "B_x": _B_in["x"],
        "B_W_gate": _B_in["W_gate"],
        "B_W_up": _B_in["W_up"],
        "B_W_down": _B_in["W_down"],
    }

def reference(A_x, A_wqkv, A_wo, B_x, B_W_gate, B_W_up, B_W_down):
    def _A_ref(x, wqkv, wo):
        B, S, D = x.shape
        H = 32; Dh = D // H
        W, dil = 8, 2
        qkv = (lambda x, *d: x.permute(*d))((x @ wqkv).reshape(B, S, 3, H, Dh), 2, 0, 3, 1, 4)
        q, k, v = qkv[0], qkv[1], qkv[2]
        scale = Dh ** -0.5
        pos = torch.arange(S)
        off = torch.arange(W) * dil
        idx = pos[:, None] - off[None, :]
        mask = idx >= 0
        idx_c = torch.where(mask, idx, 0).reshape(-1)
        kg = k[:, :, idx_c, :].reshape(B, H, S, W, Dh)
        vg = v[:, :, idx_c, :].reshape(B, H, S, W, Dh)
        logits = torch.einsum("bhsd,bhswd->bhsw", q, kg) * scale
        logits = torch.where(mask[None, None, :, :], logits, -1e9)
        attn = _softmax(logits, axis=-1)
        o = torch.einsum("bhsw,bhswd->bhsd", attn, vg)
        return (lambda x, *d: x.permute(*d))(o, 0, 2, 1, 3).reshape(B, S, D) @ wo

    def _B_ref(x, W_gate, W_up, W_down):
        gate = torch.einsum("bsd,df->bsf", x, W_gate)
        up = torch.einsum("bsd,df->bsf", x, W_up)
        gate = gate * (lambda x, dt: x.to(dt))(gate > 0, gate.dtype)
        h = gate * up
        return torch.einsum("bsf,fd->bsd", h, W_down)

    x = A_x
    h = x + _A_ref(_layernorm(x, axis=-1), A_wqkv, A_wo)
    h2 = h + _B_ref(_layernorm(h, axis=-1), B_W_gate, B_W_up, B_W_down)
    return h2
```

```asm
; @launch grid=(256,1,1) block=(512,1,1) lds=163840
.amdgcn_target "amdgcn-amd-amdhsa--gfx950"
.text
.globl sequential_preLN__sliding_local_dilated__glu_gated_reglu__prompt_kernel
.p2align 8
.type sequential_preLN__sliding_local_dilated__glu_gated_reglu__prompt_kernel,@function
sequential_preLN__sliding_local_dilated__glu_gated_reglu__prompt_kernel:
    s_cmp_ge_u32 s2, 256
    s_cbranch_scc1 K_END
    s_load_dwordx16 s[64:79], s[0:1], 0
    s_load_dwordx4 s[80:83], s[0:1], 64
    s_memrealtime s[96:97]
    s_getreg_b32 s95, hwreg(HW_REG_XCC_ID, 0, 4)
    v_lshrrev_b32 v1, 6, v0
    v_and_b32 v0, 63, v0
    v_readfirstlane_b32 s100, v1
    s_and_b32 s40, s2, 7
    s_lshr_b32 s41, s2, 3
    s_lshr_b32 s42, s41, 3
    s_and_b32 s43, s41, 7
    s_lshl_b32 s46, s40, 2
    s_add_u32 s46, s46, s42
    s_and_b32 s47, s41, 15
    s_lshr_b32 s45, s46, 1
    s_mov_b32 s48, 0x3f803f80
    s_and_b32 s44, s100, 3
    s_cmp_lt_u32 s100, 4
    s_cbranch_scc1 PROG_A
    s_lshl_b32 s50, s46, 6
    s_lshr_b32 s51, s44, 1
    s_lshl_b32 s51, s51, 5
    s_add_u32 s51, s51, s50
    s_and_b32 s52, s44, 1
    s_add_u32 s51, s51, s52
    v_lshrrev_b32 v1, 3, v0
    v_and_b32 v2, 7, v0
    v_lshrrev_b32 v3, 4, v0
    v_xor_b32 v4, v2, v3
    v_lshlrev_b32 v5, 1, v1
    v_add_u32 v5, s51, v5
    v_lshlrev_b32 v5, 10, v5
    v_lshl_add_u32 v8, v4, 4, v5
    v_xor_b32 v4, 4, v4
    v_lshl_add_u32 v9, v4, 4, v5
    v_add_u32 v9, 15360, v9
    s_lshl_b32 s52, s44, 2
    v_add_u32 v4, s52, v1
    v_lshrrev_b32 v5, 1, v4
    v_and_b32 v5, 7, v5
    v_xor_b32 v5, v5, v2
    s_sub_u32 s53, s50, 16
    v_add_u32 v4, s53, v4
    v_max_i32 v4, 0, v4
    v_lshlrev_b32 v4, 10, v4
    v_lshl_add_u32 v10, v5, 4, v4
    s_mov_b32 s58, -1
    s_cmp_eq_u32 s44, 0
    s_cselect_b32 s58, 0xffffff00, s58
    s_mov_b32 s59, 0
    s_lshl_b32 s52, s44, 3
    v_add_u32 v4, s52, v1
    v_mul_u32_u24 v4, 3072, v4
    v_and_b32 v5, 1, v3
    v_lshlrev_b32 v5, 1, v5
    s_and_b32 s52, s44, 1
    s_lshl_b32 s52, s52, 2
    v_or_b32 v5, s52, v5
    v_xor_b32 v5, v5, v2
    v_lshl_add_u32 v11, v5, 4, v4
    s_lshl_b32 s52, s43, 7
    v_add_u32 v11, s52, v11
    s_lshl_b32 s54, s41, 2
    s_add_u32 s54, s54, s44
    s_lshl_b32 s98, s54, 11
    s_mul_i32 s99, s54, 1536
    v_lshrrev_b32 v12, 2, v0
    v_lshlrev_b32 v12, 7, v12
    s_and_b32 s63, s42, 1
    s_lshl_b32 s63, s63, 2
    s_add_u32 s63, s63, s43
    s_lshl_b32 s60, s44, 11
    s_lshl_b32 s61, s44, 9
    s_add_u32 s61, s61, 8192
    s_mul_i32 s62, s44, 3072
    s_add_u32 s62, s62, 81920
    s_mov_b32 s6, 2097152
    s_mov_b32 s7, 0x20000
    s_mov_b32 s10, 1572864
    s_mov_b32 s11, 0x20000
    s_waitcnt lgkmcnt(0)
    s_mov_b32 s4, s64
    s_and_b32 s5, s65, 0xffff
    s_mov_b32 s8, s66
    s_and_b32 s9, s67, 0xffff
    s_add_u32 m0, s62, 0
    s_add_u32 s87, s63, 0
    s_and_b32 s87, s87, 7
    s_mul_i32 s56, s87, 196608
    s_lshl_b32 s87, s87, 7
    buffer_load_dwordx4 v11, s[8:11], s56 offen offset:0 lds
    buffer_load_dwordx4 v11, s[8:11], s56 offen offset:1024 lds
    buffer_load_dwordx4 v11, s[8:11], s56 offen offset:2048 lds
    s_add_u32 m0, s60, 0
    s_add_u32 s56, s56, 98304
    buffer_load_dwordx4 v8, s[4:7], s87 offen lds
    buffer_load_dwordx4 v9, s[4:7], s87 offen offset:1024 lds
    s_add_u32 m0, s61, 0
    s_mov_b64 exec, s[58:59]
    buffer_load_dwordx4 v10, s[4:7], s87 offen lds
    s_mov_b64 exec, -1
    s_add_u32 m0, s62, 12288
    s_nop 0
    buffer_load_dwordx4 v11, s[8:11], s56 offen offset:0 lds
    buffer_load_dwordx4 v11, s[8:11], s56 offen offset:1024 lds
    buffer_load_dwordx4 v11, s[8:11], s56 offen offset:2048 lds
    s_mul_i32 s50, s45, 655360
    s_add_u32 s24, s82, s50
    s_addc_u32 s25, s83, 0
    s_and_b32 s25, s25, 0xffff
    s_mov_b32 s26, 655360
    s_mov_b32 s27, 0x20000
    s_bitcmp1_b32 s44, 0
    s_cselect_b32 s32, s74, s72
    s_cselect_b32 s33, s75, s73
    s_and_b32 s33, s33, 0xffff
    s_cmp_eq_u32 s47, 15
    s_cselect_b32 s34, 0, 1409024
    s_mov_b32 s35, 0x20000
    s_mov_b32 s28, s80
    s_and_b32 s29, s81, 0xffff
    s_mov_b32 s30, 256
    s_mov_b32 s31, 0x20000
    s_mov_b32 s12, s68
    s_and_b32 s13, s69, 0xffff
    s_mov_b32 s14, 524288
    s_mov_b32 s15, 0x20000
    s_mov_b32 s16, s76
    s_and_b32 s17, s77, 0xffff
    s_mov_b32 s18, 1409024
    s_mov_b32 s19, 0x20000
    s_mov_b32 s20, s78
    s_and_b32 s21, s79, 0xffff
    s_mov_b32 s22, 2097152
    s_mov_b32 s23, 0x20000
    s_cmp_lg_u32 s44, 0
    s_cbranch_scc1 REG_DONE
    s_and_b32 s95, s95, 7
    s_mul_i32 s50, s95, s95
    s_lshl_b32 s50, s50, 12
    s_lshl_b32 s51, s95, 5
    s_or_b32 s50, s50, s51
    s_or_b32 s50, s50, 1
    s_lshl_b64 s[54:55], s[96:97], 22
    s_or_b32 s50, s50, s54
    v_mov_b32 v2, s50
    v_mov_b32 v3, s55
    s_lshl_b32 s51, s45, 3
    v_mov_b32 v4, s51
    s_mov_b64 exec, 1
    buffer_atomic_add_x2 v[2:3], v4, s[28:31], 0 offen offset:128 sc1
    s_mov_b64 exec, -1
REG_DONE:
    s_add_u32 m0, s62, 24576
    s_add_u32 s87, s63, 1
    s_and_b32 s87, s87, 7
    s_mul_i32 s56, s87, 196608
    s_lshl_b32 s87, s87, 7
    buffer_load_dwordx4 v11, s[8:11], s56 offen offset:0 lds
    buffer_load_dwordx4 v11, s[8:11], s56 offen offset:1024 lds
    buffer_load_dwordx4 v11, s[8:11], s56 offen offset:2048 lds
    s_add_u32 m0, s60, 10240
    s_add_u32 s56, s56, 98304
    buffer_load_dwordx4 v8, s[4:7], s87 offen lds
    buffer_load_dwordx4 v9, s[4:7], s87 offen offset:1024 lds
    s_add_u32 m0, s61, 10240
    s_mov_b64 exec, s[58:59]
    buffer_load_dwordx4 v10, s[4:7], s87 offen lds
    s_mov_b64 exec, -1
    s_add_u32 m0, s62, 36864
    s_nop 0
    buffer_load_dwordx4 v11, s[8:11], s56 offen offset:0 lds
    buffer_load_dwordx4 v11, s[8:11], s56 offen offset:1024 lds
    buffer_load_dwordx4 v11, s[8:11], s56 offen offset:2048 lds
    v_lshlrev_b32 v248, 4, v0
    s_lshl_b32 s50, s44, 11
    s_lshl_b32 s51, s44, 9
    s_add_u32 s51, s51, 8192
    v_add_u32 v14, s51, v248
    v_add_u32 v13, s50, v248
    v_mov_b64 v[28:29], 0
    v_mov_b64 v[30:31], 0
    v_mov_b64 v[32:33], 0
    s_waitcnt vmcnt(9)
    s_barrier
    s_add_u32 m0, s62, 49152
    s_add_u32 s87, s63, 2
    s_and_b32 s87, s87, 7
    s_mul_i32 s56, s87, 196608
    s_lshl_b32 s87, s87, 7
    buffer_load_dwordx4 v11, s[8:11], s56 offen offset:0 lds
    s_mul_i32 s50, s47, 192
    s_mov_b32 s51, 0x15555556
    s_and_b32 s52, s44, 1
    s_lshr_b32 s54, s44, 1
    s_mul_i32 s89, s52, 12288
    s_mul_i32 s55, s54, 6144
    buffer_load_dwordx4 v11, s[8:11], s56 offen offset:1024 lds
    s_add_u32 s89, s89, s55
    s_mul_i32 s90, s54, 88064
    s_and_b32 s88, s45, 1
    s_lshl_b32 s88, s88, 2
    s_lshl_b32 s52, s52, 1
    buffer_load_dwordx4 v11, s[8:11], s56 offen offset:2048 lds
    v_add_u32 v1, 0, v0
    v_mul_hi_u32 v2, v1, s51
    v_mul_u32_u24 v3, 12, v2
    v_sub_u32 v3, v1, v3
    v_mul_u32_u24 v2, 2752, v2
    v_add_u32 v2, s50, v2
    s_add_u32 m0, s60, 20480
    s_add_u32 s56, s56, 98304
    buffer_load_dwordx4 v8, s[4:7], s87 offen lds
    v_subrev_u32 v2, 0, v2
    v_subrev_u32 v3, s52, v3
    v_add_u32 v1, 12, v3
    v_cmp_gt_i32 vcc, 0, v3
    s_nop 1
    v_cndmask_b32 v3, v3, v1, vcc
    v_lshl_add_u32 v240, v3, 4, v2
    buffer_load_dwordx4 v9, s[4:7], s87 offen offset:1024 lds
    v_add_u32 v1, 64, v0
    v_mul_hi_u32 v2, v1, s51
    v_mul_u32_u24 v3, 12, v2
    v_sub_u32 v3, v1, v3
    v_mul_u32_u24 v2, 2752, v2
    s_add_u32 m0, s61, 20480
    s_mov_b64 exec, s[58:59]
    buffer_load_dwordx4 v10, s[4:7], s87 offen lds
    s_mov_b64 exec, -1
    v_add_u32 v2, s50, v2
    v_subrev_u32 v2, 1024, v2
    v_subrev_u32 v3, s52, v3
    v_add_u32 v1, 12, v3
    v_cmp_gt_i32 vcc, 0, v3
    s_nop 1
    v_cndmask_b32 v3, v3, v1, vcc
    s_add_u32 m0, s62, 61440
    s_nop 0
    buffer_load_dwordx4 v11, s[8:11], s56 offen offset:0 lds
    v_lshl_add_u32 v241, v3, 4, v2
    v_add_u32 v1, 128, v0
    v_mul_hi_u32 v2, v1, s51
    v_mul_u32_u24 v3, 12, v2
    v_sub_u32 v3, v1, v3
    buffer_load_dwordx4 v11, s[8:11], s56 offen offset:1024 lds
    v_mul_u32_u24 v2, 2752, v2
    v_add_u32 v2, s50, v2
    v_subrev_u32 v2, 2048, v2
    v_subrev_u32 v3, s52, v3
    v_add_u32 v1, 12, v3
    v_cmp_gt_i32 vcc, 0, v3
    buffer_load_dwordx4 v11, s[8:11], s56 offen offset:2048 lds
    s_nop 0
    v_cndmask_b32 v3, v3, v1, vcc
    v_lshl_add_u32 v242, v3, 4, v2
    s_waitcnt vmcnt(9)
    s_barrier
    s_add_u32 m0, s62, 0
    s_add_u32 s87, s63, 3
    s_and_b32 s87, s87, 7
    s_mul_i32 s56, s87, 196608
    s_lshl_b32 s87, s87, 7
    buffer_load_dwordx4 v11, s[8:11], s56 offen offset:0 lds
    v_lshrrev_b32 v1, 3, v0
    v_and_b32 v2, 7, v0
    buffer_load_dwordx4 v11, s[8:11], s56 offen offset:1024 lds
    v_bfe_u32 v3, v0, 4, 1
    v_lshlrev_b32 v3, 2, v3
    buffer_load_dwordx4 v11, s[8:11], s56 offen offset:2048 lds
    v_xor_b32 v2, v2, v3
    v_lshlrev_b32 v1, 10, v1
    s_add_u32 m0, s60, 30720
    s_add_u32 s56, s56, 98304
    buffer_load_dwordx4 v8, s[4:7], s87 offen lds
    v_lshl_add_u32 v243, v2, 4, v1
    s_lshl_b32 s50, s43, 7
    buffer_load_dwordx4 v9, s[4:7], s87 offen offset:1024 lds
    v_add_u32 v243, s50, v243
    s_lshl_b32 s52, s42, 1
    s_add_u32 m0, s61, 30720
    s_mov_b64 exec, s[58:59]
    buffer_load_dwordx4 v10, s[4:7], s87 offen lds
    s_mov_b64 exec, -1
    s_lshl_b32 s92, s44, 11
    s_lshl_b32 s98, s42, 13
    s_add_u32 m0, s62, 12288
    s_nop 0
    buffer_load_dwordx4 v11, s[8:11], s56 offen offset:0 lds
    s_lshl_b32 s99, s44, 10
    buffer_load_dwordx4 v11, s[8:11], s56 offen offset:1024 lds
    buffer_load_dwordx4 v11, s[8:11], s56 offen offset:2048 lds
    s_waitcnt vmcnt(9)
    s_barrier
    s_add_u32 m0, s62, 24576
    s_add_u32 s87, s63, 4
    s_and_b32 s87, s87, 7
    s_mul_i32 s56, s87, 196608
    s_lshl_b32 s87, s87, 7
    buffer_load_dwordx4 v11, s[8:11], s56 offen offset:0 lds
    v_lshrrev_b32 v1, 5, v0
    v_bfe_u32 v2, v0, 2, 2
    v_lshl_add_u32 v1, v1, 2, v2
    v_lshlrev_b32 v1, 7, v1
    v_and_b32 v2, 1, v0
    v_lshl_add_u32 v1, v2, 5, v1
    buffer_load_dwordx4 v11, s[8:11], s56 offen offset:1024 lds
    v_bfe_u32 v2, v0, 4, 1
    v_lshl_add_u32 v1, v2, 4, v1
    v_bfe_u32 v2, v0, 1, 1
    v_lshl_add_u32 v1, v2, 3, v1
    v_bfe_u32 v2, v0, 3, 1
    s_and_b32 s50, s44, 1
    buffer_load_dwordx4 v11, s[8:11], s56 offen offset:2048 lds
    v_xor_b32 v2, s50, v2
    v_lshl_add_u32 v245, v2, 6, v1
    v_add_u32 v245, s92, v245
    v_xor_b32 v244, 64, v245
    s_lshl_b32 s91, s44, 15
    s_add_u32 s91, s91, 135168
    s_add_u32 m0, s60, 40960
    s_add_u32 s56, s56, 98304
    buffer_load_dwordx4 v8, s[4:7], s87 offen lds
    s_lshl_b32 s50, s46, 6
    s_lshr_b32 s52, s44, 1
    s_lshl_b32 s52, s52, 5
    s_add_u32 s50, s50, s52
    s_lshl_b32 s50, s50, 10
    s_lshl_b32 s52, s43, 7
    buffer_load_dwordx4 v9, s[4:7], s87 offen offset:1024 lds
    s_add_u32 s50, s50, s52
    s_and_b32 s52, s44, 1
    s_lshl_b32 s52, s52, 6
    s_add_u32 s50, s50, s52
    v_and_b32 v2, 15, v0
    v_lshlrev_b32 v2, 11, v2
    s_add_u32 m0, s61, 40960
    s_mov_b64 exec, s[58:59]
    buffer_load_dwordx4 v10, s[4:7], s87 offen lds
    s_mov_b64 exec, -1
    v_lshrrev_b32 v3, 4, v0
    v_lshl_add_u32 v249, v3, 4, v2
    v_add_u32 v249, s50, v249
    s_lshl_b32 s50, s45, 3
    v_mov_b32 v15, s50
    s_and_b32 s50, s46, 1
    s_add_u32 m0, s62, 36864
    s_nop 0
    buffer_load_dwordx4 v11, s[8:11], s56 offen offset:0 lds
    s_lshl_b32 s50, s50, 1
    s_lshr_b32 s51, s44, 1
    s_add_u32 s50, s50, s51
    s_lshl_b32 s94, s50, 12
    s_lshl_b32 s93, s50, 15
    s_lshl_b32 s52, s43, 1
    buffer_load_dwordx4 v11, s[8:11], s56 offen offset:1024 lds
    s_and_b32 s53, s44, 1
    s_add_u32 s52, s52, s53
    s_lshl_b32 s52, s52, 11
    s_add_u32 s93, s93, s52
    s_add_u32 s93, s93, 135168
    s_lshl_b32 s52, s43, 9
    buffer_load_dwordx4 v11, s[8:11], s56 offen offset:2048 lds
    s_add_u32 s94, s94, s52
    s_lshl_b32 s53, s53, 3
    s_add_u32 s94, s94, s53
    s_add_u32 s94, s94, 626688
    buffer_load_dwordx2 v[246:247], v15, s[28:31], 0 offen offset:128 sc1
    s_waitcnt vmcnt(10)
    s_barrier
    s_add_u32 m0, s62, 49152
    s_add_u32 s87, s63, 5
    s_and_b32 s87, s87, 7
    s_mul_i32 s56, s87, 196608
    s_lshl_b32 s87, s87, 7
    buffer_load_dwordx4 v11, s[8:11], s56 offen offset:0 lds
    buffer_load_dwordx4 v11, s[8:11], s56 offen offset:1024 lds
    buffer_load_dwordx4 v11, s[8:11], s56 offen offset:2048 lds
    s_add_u32 m0, s60, 51200
    s_add_u32 s56, s56, 98304
    buffer_load_dwordx4 v8, s[4:7], s87 offen lds
    buffer_load_dwordx4 v9, s[4:7], s87 offen offset:1024 lds
    s_waitcnt vmcnt(5)
    s_mov_b32 s57, 0
B_REGPOLL:
    v_readfirstlane_b32 s50, v246
    v_readfirstlane_b32 s51, v247
    s_and_b32 s52, s50, 31
    s_cmp_eq_u32 s52, 16
    s_cbranch_scc1 B_REGOK
    s_add_u32 s57, s57, 1
    s_cmp_ge_u32 s57, 20000
    s_cbranch_scc1 B_REGOK
    buffer_load_dwordx2 v[246:247], v15, s[28:31], 0 offen offset:128 sc1
    s_waitcnt vmcnt(0)
    s_branch B_REGPOLL
B_REGOK:
    s_bfe_u32 s52, s50, 458757
    s_bfe_u32 s53, s50, 655372
    s_mul_i32 s52, s52, s52
    s_lshl_b32 s53, s53, 4
    s_cmp_lg_u32 s52, s53
    s_cselect_b32 s49, 1, 0
    s_and_b32 s50, s50, 0xffc00000
    s_or_b32 s50, s50, 0x5a5a0
    v_mov_b32 v246, s50
    v_mov_b32 v247, s51
    v_min_u32 v2, 2, v0
    s_mul_i32 s50, s44, 24
    s_add_u32 s50, s50, 156544
    v_lshlrev_b32 v3, 3, v2
    v_add_u32 v3, s50, v3
    ds_read_b64 v[16:17], v3
    s_mul_i32 s50, s43, 10
    s_mul_i32 s51, s44, 3
    s_add_u32 s50, s50, s51
    v_add_u32 v2, s50, v2
    v_min_u32 v2, 79, v2
    v_lshlrev_b32 v2, 4, v2
    s_and_b32 s54, s46, 1
    s_mul_i32 s54, s54, 1280
    s_add_u32 s54, s54, 645120
    v_mov_b32 v18, v246
    v_mov_b32 v19, v247
    v_min_u32 v20, 19, v0
    s_mul_i32 s50, s44, 20
    v_add_u32 v20, s50, v20
    v_lshlrev_b32 v21, 2, v20
    v_add_u32 v21, 155648, v21
    v_lshlrev_b32 v20, 4, v20
    s_mov_b32 s86, s54
    s_waitcnt lgkmcnt(0)
    s_cmp_lg_u32 s49, 0
    s_cbranch_scc1 B_STG_SLOW
    buffer_store_dwordx4 v[16:19], v2, s[24:27], s54 offen
    s_branch B_STG_DONE
B_STG_SLOW:
    buffer_store_dwordx4 v[16:19], v2, s[24:27], s54 offen sc1
B_STG_DONE:
    s_add_u32 m0, s61, 51200
    s_mov_b64 exec, s[58:59]
    buffer_load_dwordx4 v10, s[4:7], s87 offen lds
    s_mov_b64 exec, -1
    s_add_u32 m0, s62, 61440
    s_nop 0
    buffer_load_dwordx4 v11, s[8:11], s56 offen offset:0 lds
    buffer_load_dwordx4 v11, s[8:11], s56 offen offset:1024 lds
    buffer_load_dwordx4 v11, s[8:11], s56 offen offset:2048 lds
    s_barrier
    s_add_u32 m0, s62, 0
    s_add_u32 s87, s63, 6
    s_and_b32 s87, s87, 7
    s_mul_i32 s56, s87, 196608
    s_lshl_b32 s87, s87, 7
    buffer_load_dwordx4 v11, s[8:11], s56 offen offset:0 lds
    buffer_load_dwordx4 v11, s[8:11], s56 offen offset:1024 lds
    buffer_load_dwordx4 v11, s[8:11], s56 offen offset:2048 lds
    s_add_u32 m0, s60, 61440
    s_add_u32 s56, s56, 98304
    buffer_load_dwordx4 v8, s[4:7], s87 offen lds
    buffer_load_dwordx4 v9, s[4:7], s87 offen offset:1024 lds
    s_add_u32 m0, s61, 61440
    s_mov_b64 exec, s[58:59]
    buffer_load_dwordx4 v10, s[4:7], s87 offen lds
    s_mov_b64 exec, -1
    s_add_u32 m0, s62, 12288
    s_nop 0
    buffer_load_dwordx4 v11, s[8:11], s56 offen offset:0 lds
    buffer_load_dwordx4 v11, s[8:11], s56 offen offset:1024 lds
    buffer_load_dwordx4 v11, s[8:11], s56 offen offset:2048 lds
    s_and_b32 s50, s42, 1
    s_mul_i32 s50, s50, 40960
    s_lshr_b32 s51, s44, 1
    s_lshl_b32 s51, s51, 12
    s_add_u32 s50, s50, s51
    v_and_b32 v2, 31, v0
    v_lshlrev_b32 v3, 7, v2
    v_add_u32 v3, s50, v3
    v_bfe_u32 v2, v0, 1, 3
    v_lshrrev_b32 v4, 5, v0
    v_lshlrev_b32 v4, 1, v4
    s_and_b32 s51, s44, 1
    s_lshl_b32 s51, s51, 2
    v_or_b32 v4, s51, v4
    v_xor_b32 v4, v4, v2
    v_lshl_add_u32 v5, v4, 4, v3
    v_xor_b32 v4, 1, v4
    v_lshl_add_u32 v3, v4, 4, v3
    ds_read_b128 v[224:227], v5
    ds_read_b128 v[228:231], v3
    s_waitcnt lgkmcnt(0)
    s_waitcnt vmcnt(9)
    s_barrier
    s_add_u32 m0, s62, 24576
    s_add_u32 s87, s63, 7
    s_and_b32 s87, s87, 7
    s_mul_i32 s56, s87, 196608
    s_lshl_b32 s87, s87, 7
    buffer_load_dwordx4 v11, s[8:11], s56 offen offset:0 lds
    buffer_load_dwordx4 v11, s[8:11], s56 offen offset:1024 lds
    buffer_load_dwordx4 v11, s[8:11], s56 offen offset:2048 lds
    s_add_u32 m0, s60, 71680
    s_add_u32 s56, s56, 98304
    buffer_load_dwordx4 v8, s[4:7], s87 offen lds
    buffer_load_dwordx4 v9, s[4:7], s87 offen offset:1024 lds
    s_add_u32 m0, s61, 71680
    s_mov_b64 exec, s[58:59]
    buffer_load_dwordx4 v10, s[4:7], s87 offen lds
    s_mov_b64 exec, -1
    s_add_u32 m0, s62, 36864
    s_nop 0
    buffer_load_dwordx4 v11, s[8:11], s56 offen offset:0 lds
    buffer_load_dwordx4 v11, s[8:11], s56 offen offset:1024 lds
    buffer_load_dwordx4 v11, s[8:11], s56 offen offset:2048 lds
    buffer_load_dwordx4 v[24:27], v20, s[24:27], s86 offen sc1
    s_waitcnt vmcnt(10)
    s_barrier
    s_add_u32 s56, s98, 0
    s_and_b32 s56, s56, 32767
    s_add_u32 s56, s56, s99
    s_lshl_b32 s56, s56, 4
    s_add_u32 m0, s92, 0
    s_add_u32 s87, s56, 7168
    buffer_load_dwordx4 v243, s[12:15], s56 offen lds
    buffer_load_dwordx4 v243, s[12:15], s87 offen offset:1024 lds
    s_add_u32 s56, s98, 4096
    s_and_b32 s56, s56, 32767
    s_add_u32 s56, s56, s99
    s_lshl_b32 s56, s56, 4
    s_add_u32 m0, s92, 8192
    s_add_u32 s87, s56, 7168
    buffer_load_dwordx4 v243, s[12:15], s56 offen lds
    buffer_load_dwordx4 v243, s[12:15], s87 offen offset:1024 lds
    s_add_u32 s56, s98, 8192
    s_and_b32 s56, s56, 32767
    s_add_u32 s56, s56, s99
    s_lshl_b32 s56, s56, 4
    s_add_u32 m0, s92, 16384
    s_add_u32 s87, s56, 7168
    buffer_load_dwordx4 v243, s[12:15], s56 offen lds
    buffer_load_dwordx4 v243, s[12:15], s87 offen offset:1024 lds
    s_add_u32 s56, s98, 12288
    s_and_b32 s56, s56, 32767
    s_add_u32 s56, s56, s99
    s_lshl_b32 s56, s56, 4
    s_add_u32 m0, s92, 24576
    s_add_u32 s87, s56, 7168
    buffer_load_dwordx4 v243, s[12:15], s56 offen lds
    buffer_load_dwordx4 v243, s[12:15], s87 offen offset:1024 lds
    s_add_u32 s56, s98, 16384
    s_and_b32 s56, s56, 32767
    s_add_u32 s56, s56, s99
    s_lshl_b32 s56, s56, 4
    s_add_u32 m0, s92, 32768
    s_add_u32 s87, s56, 7168
    buffer_load_dwordx4 v243, s[12:15], s56 offen lds
    v_and_b32 v2, 3, v0
    v_lshlrev_b32 v2, 7, v2
    v_add_u32 v2, s94, v2
    v_and_b32 v3, 15, v0
    v_lshlrev_b32 v3, 7, v3
    v_add_u32 v3, 643072, v3
    v_cmp_gt_u32 vcc, 16, v0
    s_nop 1
    v_cndmask_b32 v2, v2, v3, vcc
    buffer_load_dword v250, v2, s[24:27], 0 offen sc1
    s_waitcnt vmcnt(11)
    s_barrier
    buffer_load_dwordx4 v243, s[12:15], s87 offen offset:1024 lds
    s_add_u32 s56, s98, 20480
    s_and_b32 s56, s56, 32767
    s_add_u32 s56, s56, s99
    s_lshl_b32 s56, s56, 4
    s_add_u32 m0, s92, 40960
    s_add_u32 s87, s56, 7168
    buffer_load_dwordx4 v243, s[12:15], s56 offen lds
    buffer_load_dwordx4 v243, s[12:15], s87 offen offset:1024 lds
    s_add_u32 s56, s98, 24576
    s_and_b32 s56, s56, 32767
    s_add_u32 s56, s56, s99
    s_lshl_b32 s56, s56, 4
    s_add_u32 m0, s92, 49152
    s_add_u32 s87, s56, 7168
    buffer_load_dwordx4 v243, s[12:15], s56 offen lds
    s_waitcnt vmcnt(14)
    s_mov_b32 s57, 0
SGPOLL:
    v_cmp_ne_u64 vcc, v[26:27], v[246:247]
    s_add_u32 s57, s57, 1
    s_cbranch_vccz SGOK
    s_cmp_ge_u32 s57, 20000
    s_cbranch_scc1 SGOK
    buffer_load_dwordx4 v[24:27], v20, s[24:27], s86 offen sc1
    s_waitcnt vmcnt(0)
    s_branch SGPOLL
SGOK:
    ds_write_b32 v21, v25
    ds_write_b32 v21, v24 offset:512
    s_waitcnt lgkmcnt(0)
    s_barrier
    buffer_load_dwordx4 v243, s[12:15], s87 offen offset:1024 lds
    s_xor_b32 s56, s88, 0
    s_mul_i32 s56, s56, 176128
    s_add_u32 s56, s56, s90
    s_add_u32 m0, s89, 131072
    s_add_u32 s87, s56, 44032
    buffer_load_dwordx4 v240, s[32:35], s56 offen lds
    buffer_load_dwordx4 v241, s[32:35], s56 offen offset:1024 lds
    buffer_load_dwordx4 v242, s[32:35], s56 offen offset:2048 lds
    s_add_u32 m0, s89, 134144
    s_nop 0
    buffer_load_dwordx4 v240, s[32:35], s87 offen lds
    buffer_load_dwordx4 v241, s[32:35], s87 offen offset:1024 lds
    buffer_load_dwordx4 v242, s[32:35], s87 offen offset:2048 lds
    s_add_u32 s56, s98, 28672
    s_and_b32 s56, s56, 32767
    s_add_u32 s56, s56, s99
    s_lshl_b32 s56, s56, 4
    s_add_u32 m0, s92, 57344
    s_add_u32 s87, s56, 7168
    buffer_load_dwordx4 v243, s[12:15], s56 offen lds
    buffer_load_dwordx4 v243, s[12:15], s87 offen offset:1024 lds
    s_xor_b32 s56, s88, 1
    s_mul_i32 s56, s56, 176128
    s_add_u32 s56, s56, s90
    s_add_u32 m0, s89, 81920
    s_add_u32 s87, s56, 44032
    buffer_load_dwordx4 v240, s[32:35], s56 offen lds
    buffer_load_dwordx4 v241, s[32:35], s56 offen offset:1024 lds
    buffer_load_dwordx4 v242, s[32:35], s56 offen offset:2048 lds
    s_add_u32 m0, s89, 84992
    s_nop 0
    buffer_load_dwordx4 v240, s[32:35], s87 offen lds
    buffer_load_dwordx4 v241, s[32:35], s87 offen offset:1024 lds
    buffer_load_dwordx4 v242, s[32:35], s87 offen offset:2048 lds
    s_mul_i32 s50, s42, 11
    s_lshr_b32 s50, s50, 1
    s_lshl_b32 s50, s50, 12
    s_lshl_b32 s51, s44, 10
    s_add_u32 s64, s50, s51
    s_add_u32 s50, s50, 4096
    s_cmp_eq_u32 s50, 90112
    s_cselect_b32 s50, 0, s50
    s_add_u32 s65, s50, s51
    s_add_u32 s50, s50, 4096
    s_cmp_eq_u32 s50, 90112
    s_cselect_b32 s50, 0, s50
    s_add_u32 s66, s50, s51
    s_add_u32 s50, s50, 4096
    s_cmp_eq_u32 s50, 90112
    s_cselect_b32 s50, 0, s50
    s_add_u32 s67, s50, s51
    s_add_u32 s50, s50, 4096
    s_cmp_eq_u32 s50, 90112
    s_cselect_b32 s50, 0, s50
    s_add_u32 s68, s50, s51
    s_add_u32 s50, s50, 4096
    s_cmp_eq_u32 s50, 90112
    s_cselect_b32 s50, 0, s50
    s_add_u32 s69, s50, s51
    s_add_u32 s50, s50, 4096
    s_cmp_eq_u32 s50, 90112
    s_cselect_b32 s50, 0, s50
    s_add_u32 s70, s50, s51
    s_add_u32 s50, s50, 4096
    s_cmp_eq_u32 s50, 90112
    s_cselect_b32 s50, 0, s50
    s_add_u32 s71, s50, s51
    s_add_u32 s50, s50, 4096
    s_cmp_eq_u32 s50, 90112
    s_cselect_b32 s50, 0, s50
    s_add_u32 s72, s50, s51
    s_add_u32 s50, s50, 4096
    s_cmp_eq_u32 s50, 90112
    s_cselect_b32 s50, 0, s50
    s_add_u32 s73, s50, s51
    s_add_u32 s50, s50, 4096
    s_cmp_eq_u32 s50, 90112
    s_cselect_b32 s50, 0, s50
    s_add_u32 s74, s50, s51
    s_add_u32 s50, s50, 4096
    s_cmp_eq_u32 s50, 90112
    s_cselect_b32 s50, 0, s50
    s_add_u32 s75, s50, s51
    s_add_u32 s50, s50, 4096
    s_cmp_eq_u32 s50, 90112
    s_cselect_b32 s50, 0, s50
    s_add_u32 s76, s50, s51
    s_add_u32 s50, s50, 4096
    s_cmp_eq_u32 s50, 90112
    s_cselect_b32 s50, 0, s50
    s_add_u32 s77, s50, s51
    s_add_u32 s50, s50, 4096
    s_cmp_eq_u32 s50, 90112
    s_cselect_b32 s50, 0, s50
    s_add_u32 s78, s50, s51
    s_add_u32 s50, s50, 4096
    s_cmp_eq_u32 s50, 90112
    s_cselect_b32 s50, 0, s50
    s_add_u32 s79, s50, s51
    s_add_u32 s50, s50, 4096
    s_cmp_eq_u32 s50, 90112
    s_cselect_b32 s50, 0, s50
    s_add_u32 s80, s50, s51
    s_add_u32 s50, s50, 4096
    s_cmp_eq_u32 s50, 90112
    s_cselect_b32 s50, 0, s50
    s_add_u32 s81, s50, s51
    s_add_u32 s50, s50, 4096
    s_cmp_eq_u32 s50, 90112
    s_cselect_b32 s50, 0, s50
    s_add_u32 s82, s50, s51
    s_add_u32 s50, s50, 4096
    s_cmp_eq_u32 s50, 90112
    s_cselect_b32 s50, 0, s50
    s_add_u32 s83, s50, s51
    s_add_u32 s50, s50, 4096
    s_cmp_eq_u32 s50, 90112
    s_cselect_b32 s50, 0, s50
    s_add_u32 s84, s50, s51
    s_add_u32 s50, s50, 4096
    s_cmp_eq_u32 s50, 90112
    s_cselect_b32 s50, 0, s50
    s_add_u32 s85, s50, s51
    s_add_u32 s50, s50, 4096
    s_cmp_eq_u32 s50, 90112
    s_cselect_b32 s50, 0, s50
    v_mov_b32 v11, v248
    v_and_b32 v14, 31, v0
    v_lshlrev_b32 v14, 4, v14
    v_lshrrev_b32 v3, 5, v0
    v_lshl_add_u32 v14, v3, 2, v14
    v_subrev_u32 v12, s92, v245
    s_lshr_b32 s50, s44, 1
    s_lshl_b32 s50, s50, 15
    v_add_u32 v13, s50, v248
    s_waitcnt vmcnt(6)
    v_mov_b32 v2, 156648
    v_mov_b32 v3, 1
    s_mov_b64 exec, 1
    ds_add_u32 v2, v3
    s_mov_b64 exec, -1
    s_mov_b32 s57, 0
BS_wo:
    ds_read_b32 v3, v2
    s_add_u32 s57, s57, 1
    s_waitcnt lgkmcnt(0)
    v_readfirstlane_b32 s55, v3
    s_cmp_ge_u32 s57, 0x100000
    s_cbranch_scc1 BS_wo_D
    s_cmp_lt_u32 s55, 4
    s_cbranch_scc1 BS_wo
BS_wo_D:
    ds_read_b64_tr_b16 v[80:81], v12 offset:0
    ds_read_b64_tr_b16 v[82:83], v12 offset:1024
    ds_read_b64_tr_b16 v[84:85], v12 offset:2048
    ds_read_b64_tr_b16 v[86:87], v12 offset:3072
    ds_read_b64_tr_b16 v[88:89], v12 offset:4096
    ds_read_b64_tr_b16 v[90:91], v12 offset:5120
    ds_read_b64_tr_b16 v[92:93], v12 offset:6144
    ds_read_b64_tr_b16 v[94:95], v12 offset:7168
    ds_read_b64_tr_b16 v[96:97], v12 offset:8192
    ds_read_b64_tr_b16 v[98:99], v12 offset:9216
    ds_read_b64_tr_b16 v[100:101], v12 offset:10240
    ds_read_b64_tr_b16 v[102:103], v12 offset:11264
    ds_read_b64_tr_b16 v[104:105], v12 offset:12288
    ds_read_b64_tr_b16 v[106:107], v12 offset:13312
    ds_read_b64_tr_b16 v[108:109], v12 offset:14336
    ds_read_b64_tr_b16 v[110:111], v12 offset:15360
    ds_read_b64_tr_b16 v[112:113], v12 offset:16384
    ds_read_b64_tr_b16 v[114:115], v12 offset:17408
    ds_read_b64_tr_b16 v[116:117], v12 offset:18432
    ds_read_b64_tr_b16 v[118:119], v12 offset:19456
    ds_read_b64_tr_b16 v[120:121], v12 offset:20480
    ds_read_b64_tr_b16 v[122:123], v12 offset:21504
    ds_read_b64_tr_b16 v[124:125], v12 offset:22528
    ds_read_b64_tr_b16 v[126:127], v12 offset:23552
    ds_read_b64_tr_b16 v[128:129], v12 offset:24576
    ds_read_b64_tr_b16 v[130:131], v12 offset:25600
    ds_read_b64_tr_b16 v[132:133], v12 offset:26624
    ds_read_b64_tr_b16 v[134:135], v12 offset:27648
    ds_read_b64_tr_b16 v[136:137], v12 offset:28672
    ds_read_b64_tr_b16 v[138:139], v12 offset:29696
    ds_read_b64_tr_b16 v[140:141], v12 offset:30720
    ds_read_b64_tr_b16 v[142:143], v12 offset:31744
    ds_read_b64_tr_b16 v[144:145], v12 offset:32768
    ds_read_b64_tr_b16 v[146:147], v12 offset:33792
    ds_read_b64_tr_b16 v[148:149], v12 offset:34816
    ds_read_b64_tr_b16 v[150:151], v12 offset:35840
    ds_read_b64_tr_b16 v[152:153], v12 offset:36864
    ds_read_b64_tr_b16 v[154:155], v12 offset:37888
    ds_read_b64_tr_b16 v[156:157], v12 offset:38912
    ds_read_b64_tr_b16 v[158:159], v12 offset:39936
    ds_read_b64_tr_b16 v[160:161], v12 offset:40960
    ds_read_b64_tr_b16 v[162:163], v12 offset:41984
    ds_read_b64_tr_b16 v[164:165], v12 offset:43008
    ds_read_b64_tr_b16 v[166:167], v12 offset:44032
    ds_read_b64_tr_b16 v[168:169], v12 offset:45056
    ds_read_b64_tr_b16 v[170:171], v12 offset:46080
    ds_read_b64_tr_b16 v[172:173], v12 offset:47104
    ds_read_b64_tr_b16 v[174:175], v12 offset:48128
    ds_read_b64_tr_b16 v[176:177], v12 offset:49152
    ds_read_b64_tr_b16 v[178:179], v12 offset:50176
    ds_read_b64_tr_b16 v[180:181], v12 offset:51200
    ds_read_b64_tr_b16 v[182:183], v12 offset:52224
    ds_read_b64_tr_b16 v[184:185], v12 offset:53248
    ds_read_b64_tr_b16 v[186:187], v12 offset:54272
    ds_read_b64_tr_b16 v[188:189], v12 offset:55296
    ds_read_b64_tr_b16 v[190:191], v12 offset:56320
    ds_read_b64_tr_b16 v[192:193], v12 offset:57344
    ds_read_b64_tr_b16 v[194:195], v12 offset:58368
    ds_read_b64_tr_b16 v[196:197], v12 offset:59392
    ds_read_b64_tr_b16 v[198:199], v12 offset:60416
    ds_read_b64_tr_b16 v[200:201], v12 offset:61440
    ds_read_b64_tr_b16 v[202:203], v12 offset:62464
    ds_read_b64_tr_b16 v[204:205], v12 offset:63488
    ds_read_b64_tr_b16 v[206:207], v12 offset:64512
    v_lshlrev_b32 v32, 16, v224
    v_and_b32 v33, 0xffff0000, v224
    v_lshlrev_b32 v34, 16, v225
    v_and_b32 v35, 0xffff0000, v225
    v_lshlrev_b32 v36, 16, v226
    v_and_b32 v37, 0xffff0000, v226
    v_lshlrev_b32 v38, 16, v227
    v_and_b32 v39, 0xffff0000, v227
    v_lshlrev_b32 v40, 16, v228
    v_and_b32 v41, 0xffff0000, v228
    v_lshlrev_b32 v42, 16, v229
    v_and_b32 v43, 0xffff0000, v229
    v_lshlrev_b32 v44, 16, v230
    v_and_b32 v45, 0xffff0000, v230
    v_lshlrev_b32 v46, 16, v231
    v_and_b32 v47, 0xffff0000, v231
    s_waitcnt vmcnt(0)
    s_waitcnt lgkmcnt(0)
    s_barrier
    s_barrier
    ds_read_b128 v[48:51], v13 offset:0
    ds_read_b128 v[52:55], v13 offset:1024
    ds_read_b128 v[56:59], v13 offset:2048
    ds_read_b128 v[60:63], v13 offset:3072
    ds_read_b128 v[64:67], v13 offset:4096
    s_waitcnt lgkmcnt(4)
    v_mfma_f32_32x32x16_bf16 v[32:47], v[80:83], v[48:51], v[32:47]
    ds_read_b128 v[68:71], v13 offset:5120
    s_waitcnt lgkmcnt(4)
    v_mfma_f32_32x32x16_bf16 v[32:47], v[84:87], v[52:55], v[32:47]
    ds_read_b128 v[48:51], v13 offset:6144
    s_waitcnt lgkmcnt(4)
    v_mfma_f32_32x32x16_bf16 v[32:47], v[88:91], v[56:59], v[32:47]
    ds_read_b128 v[52:55], v13 offset:7168
    s_waitcnt lgkmcnt(4)
    v_mfma_f32_32x32x16_bf16 v[32:47], v[92:95], v[60:63], v[32:47]
    s_barrier
    ds_read_b128 v[56:59], v13 offset:8192
    s_waitcnt lgkmcnt(4)
    v_mfma_f32_32x32x16_bf16 v[32:47], v[96:99], v[64:67], v[32:47]
    ds_read_b128 v[60:63], v13 offset:9216
    s_waitcnt lgkmcnt(4)
    v_mfma_f32_32x32x16_bf16 v[32:47], v[100:103], v[68:71], v[32:47]
    ds_read_b128 v[64:67], v13 offset:10240
    s_waitcnt lgkmcnt(4)
    v_mfma_f32_32x32x16_bf16 v[32:47], v[104:107], v[48:51], v[32:47]
    ds_read_b128 v[68:71], v13 offset:11264
    s_waitcnt lgkmcnt(4)
    v_mfma_f32_32x32x16_bf16 v[32:47], v[108:111], v[52:55], v[32:47]
    ds_read_b128 v[48:51], v13 offset:12288
    s_waitcnt lgkmcnt(4)
    v_mfma_f32_32x32x16_bf16 v[32:47], v[112:115], v[56:59], v[32:47]
    ds_read_b128 v[52:55], v13 offset:13312
    s_waitcnt lgkmcnt(4)
    v_mfma_f32_32x32x16_bf16 v[32:47], v[116:119], v[60:63], v[32:47]
    ds_read_b128 v[56:59], v13 offset:14336
    s_waitcnt lgkmcnt(4)
    v_mfma_f32_32x32x16_bf16 v[32:47], v[120:123], v[64:67], v[32:47]
    ds_read_b128 v[60:63], v13 offset:15360
    s_waitcnt lgkmcnt(4)
    v_mfma_f32_32x32x16_bf16 v[32:47], v[124:127], v[68:71], v[32:47]
    s_barrier
    ds_read_b128 v[64:67], v13 offset:16384
    s_waitcnt lgkmcnt(4)
    v_mfma_f32_32x32x16_bf16 v[32:47], v[128:131], v[48:51], v[32:47]
    ds_read_b128 v[68:71], v13 offset:17408
    s_waitcnt lgkmcnt(4)
    v_mfma_f32_32x32x16_bf16 v[32:47], v[132:135], v[52:55], v[32:47]
    ds_read_b128 v[48:51], v13 offset:18432
    s_waitcnt lgkmcnt(4)
    v_mfma_f32_32x32x16_bf16 v[32:47], v[136:139], v[56:59], v[32:47]
    ds_read_b128 v[52:55], v13 offset:19456
    s_waitcnt lgkmcnt(4)
    v_mfma_f32_32x32x16_bf16 v[32:47], v[140:143], v[60:63], v[32:47]
    ds_read_b128 v[56:59], v13 offset:20480
    s_waitcnt lgkmcnt(4)
    v_mfma_f32_32x32x16_bf16 v[32:47], v[144:147], v[64:67], v[32:47]
    ds_read_b128 v[60:63], v13 offset:21504
    s_waitcnt lgkmcnt(4)
    v_mfma_f32_32x32x16_bf16 v[32:47], v[148:151], v[68:71], v[32:47]
    ds_read_b128 v[64:67], v13 offset:22528
    s_waitcnt lgkmcnt(4)
    v_mfma_f32_32x32x16_bf16 v[32:47], v[152:155], v[48:51], v[32:47]
    ds_read_b128 v[68:71], v13 offset:23552
    s_waitcnt lgkmcnt(4)
    v_mfma_f32_32x32x16_bf16 v[32:47], v[156:159], v[52:55], v[32:47]
    s_barrier
    ds_read_b128 v[48:51], v13 offset:24576
    s_waitcnt lgkmcnt(4)
    v_mfma_f32_32x32x16_bf16 v[32:47], v[160:163], v[56:59], v[32:47]
    ds_read_b128 v[52:55], v13 offset:25600
    s_waitcnt lgkmcnt(4)
    v_mfma_f32_32x32x16_bf16 v[32:47], v[164:167], v[60:63], v[32:47]
    ds_read_b128 v[56:59], v13 offset:26624
    s_waitcnt lgkmcnt(4)
    v_mfma_f32_32x32x16_bf16 v[32:47], v[168:171], v[64:67], v[32:47]
    ds_read_b128 v[60:63], v13 offset:27648
    s_waitcnt lgkmcnt(4)
    v_mfma_f32_32x32x16_bf16 v[32:47], v[172:175], v[68:71], v[32:47]
    ds_read_b128 v[64:67], v13 offset:28672
    s_waitcnt lgkmcnt(4)
    v_mfma_f32_32x32x16_bf16 v[32:47], v[176:179], v[48:51], v[32:47]
    ds_read_b128 v[68:71], v13 offset:29696
    s_waitcnt lgkmcnt(4)
    v_mfma_f32_32x32x16_bf16 v[32:47], v[180:183], v[52:55], v[32:47]
    ds_read_b128 v[48:51], v13 offset:30720
    s_waitcnt lgkmcnt(4)
    v_mfma_f32_32x32x16_bf16 v[32:47], v[184:187], v[56:59], v[32:47]
    ds_read_b128 v[52:55], v13 offset:31744
    s_waitcnt lgkmcnt(4)
    v_mfma_f32_32x32x16_bf16 v[32:47], v[188:191], v[60:63], v[32:47]
    s_waitcnt lgkmcnt(3)
    v_mfma_f32_32x32x16_bf16 v[32:47], v[192:195], v[64:67], v[32:47]
    s_waitcnt lgkmcnt(2)
    v_mfma_f32_32x32x16_bf16 v[32:47], v[196:199], v[68:71], v[32:47]
    s_waitcnt lgkmcnt(1)
    v_mfma_f32_32x32x16_bf16 v[32:47], v[200:203], v[48:51], v[32:47]
    s_waitcnt lgkmcnt(0)
    v_mfma_f32_32x32x16_bf16 v[32:47], v[204:207], v[52:55], v[32:47]
    v_mov_b64 v[16:17], 0
    v_mov_b64 v[18:19], 0
    s_nop 9
    v_cvt_pk_bf16_f32 v232, v32, v33
    v_cvt_pk_bf16_f32 v233, v34, v35
    v_cvt_pk_bf16_f32 v234, v36, v37
    v_cvt_pk_bf16_f32 v235, v38, v39
    v_cvt_pk_bf16_f32 v236, v40, v41
    v_cvt_pk_bf16_f32 v237, v42, v43
    v_cvt_pk_bf16_f32 v238, v44, v45
    v_cvt_pk_bf16_f32 v239, v46, v47
    buffer_store_dwordx4 v[232:235], v248, s[24:27], s93 offen sc1
    buffer_store_dwordx4 v[236:239], v248, s[24:27], s93 offen offset:1024 sc1
B_ST2_DONE:
    v_dot2c_f32_bf16 v16, s48, v232
    v_dot2c_f32_bf16 v17, v232, v232
    v_dot2c_f32_bf16 v18, s48, v233
    v_dot2c_f32_bf16 v19, v233, v233
    v_dot2c_f32_bf16 v16, s48, v234
    v_dot2c_f32_bf16 v17, v234, v234
    v_dot2c_f32_bf16 v18, s48, v235
    v_dot2c_f32_bf16 v19, v235, v235
    v_dot2c_f32_bf16 v16, s48, v236
    v_dot2c_f32_bf16 v17, v236, v236
    v_dot2c_f32_bf16 v18, s48, v237
    v_dot2c_f32_bf16 v19, v237, v237
    v_dot2c_f32_bf16 v16, s48, v238
    v_dot2c_f32_bf16 v17, v238, v238
    v_dot2c_f32_bf16 v18, s48, v239
    v_dot2c_f32_bf16 v19, v239, v239
    s_nop 1
    v_add_f32 v16, v16, v18
    v_add_f32 v17, v17, v19
    s_nop 1
    v_permlane32_swap_b32 v16, v17
    v_add_f32 v16, v16, v17
    s_cmp_lg_u32 s49, 0
    s_cbranch_scc1 B_ST2B_SLOW
    buffer_store_dword v16, v14, s[24:27], s94 offen
    s_branch B_ST2B_DONE
B_ST2B_SLOW:
    buffer_store_dword v16, v14, s[24:27], s94 offen sc1
B_ST2B_DONE:
    v_add_u32 v2, 1, v246
    v_mov_b32 v3, v247
    s_lshl_b32 s50, s47, 2
    s_add_u32 s50, s50, s44
    s_lshl_b32 s50, s50, 3
    s_add_u32 s50, s50, 643584
    v_mov_b32 v4, s50
    s_waitcnt vmcnt(0)
    s_mov_b64 exec, 1
    s_cmp_lg_u32 s49, 0
    s_cbranch_scc1 B_SIG1_SLOW
    buffer_store_dwordx2 v[2:3], v4, s[24:27], 0 offen
    s_branch B_SIG1_DONE
B_SIG1_SLOW:
    buffer_store_dwordx2 v[2:3], v4, s[24:27], 0 offen sc1
B_SIG1_DONE:
    s_mov_b64 exec, -1
    s_mul_i32 s50, s44, 6144
    s_add_u32 s50, s50, 49152
    s_add_u32 s92, s92, s50
    v_add_u32 v24, s50, v244
    v_add_u32 v25, s50, v245
    v_mov_b32 v20, v240
    v_mov_b32 v21, v241
    v_mov_b32 v22, v242
    v_mov_b32 v23, v243
    v_mov_b32 v1, v249
    s_mov_b32 s8, s24
    s_mov_b32 s9, s25
    s_cmp_eq_u32 s47, 15
    s_cselect_b32 s10, 0, 655360
    s_lshl_b32 s54, s44, 12
    s_add_u32 s54, s54, 626688
    v_mov_b32 v15, v253
    v_lshlrev_b32 v4, 3, v0
    v_add_u32 v2, 1, v246
    v_mov_b32 v3, v247
    s_mov_b32 s57, 0
    s_mov_b32 s50, 643584
POLL1:
    buffer_load_dwordx2 v[6:7], v4, s[24:27], s50 offen sc1
    s_add_u32 s57, s57, 1
    s_waitcnt vmcnt(0)
    v_cmp_ne_u64 vcc, v[6:7], v[2:3]
    s_cmp_ge_u32 s57, 20000
    s_cbranch_scc1 POLL1_DONE
    s_cbranch_vccnz POLL1
POLL1_DONE:
    s_xor_b32 s56, s88, 0
    s_lshl_b32 s56, s56, 12
    s_add_u32 s56, s56, s91
    s_lshl_b32 s87, s44, 12
    s_add_u32 m0, s87, 0
    s_nop 0
    buffer_load_dwordx4 v11, s[8:11], s56 offen sc1 lds
    buffer_load_dwordx4 v11, s[8:11], s56 offen offset:1024 sc1 lds
    buffer_load_dwordx4 v11, s[8:11], s56 offen offset:2048 sc1 lds
    buffer_load_dwordx4 v11, s[8:11], s56 offen offset:3072 sc1 lds
    s_xor_b32 s56, s88, 1
    s_lshl_b32 s56, s56, 12
    s_add_u32 s56, s56, s91
    s_lshl_b32 s87, s44, 12
    s_add_u32 m0, s87, 16384
    s_nop 0
    buffer_load_dwordx4 v11, s[8:11], s56 offen sc1 lds
    buffer_load_dwordx4 v11, s[8:11], s56 offen offset:1024 sc1 lds
    s_waitcnt vmcnt(2)
    s_barrier
    buffer_load_dwordx4 v11, s[8:11], s56 offen offset:2048 sc1 lds
    buffer_load_dwordx4 v11, s[8:11], s56 offen offset:3072 sc1 lds
    s_xor_b32 s56, s88, 4
    s_lshl_b32 s56, s56, 12
    s_add_u32 s56, s56, s91
    s_lshl_b32 s87, s44, 12
    s_add_u32 m0, s87, 32768
    s_nop 0
    buffer_load_dwordx4 v11, s[8:11], s56 offen sc1 lds
    buffer_load_dwordx4 v11, s[8:11], s56 offen offset:1024 sc1 lds
    buffer_load_dwordx4 v11, s[8:11], s56 offen offset:2048 sc1 lds
    buffer_load_dwordx4 v11, s[8:11], s56 offen offset:3072 sc1 lds
    buffer_load_dwordx4 v[32:35], v11, s[24:27], s54 offen offset:0 sc1
    buffer_load_dwordx4 v[36:39], v11, s[24:27], s54 offen offset:1024 sc1
    buffer_load_dwordx4 v[40:43], v11, s[24:27], s54 offen offset:2048 sc1
    buffer_load_dwordx4 v[44:47], v11, s[24:27], s54 offen offset:3072 sc1
    s_xor_b32 s56, s88, 2
    s_mul_i32 s56, s56, 176128
    s_add_u32 s56, s56, s90
    s_add_u32 m0, s89, 81920
    s_add_u32 s87, s56, 44032
    buffer_load_dwordx4 v20, s[32:35], s56 offen lds
    buffer_load_dwordx4 v21, s[32:35], s56 offen offset:1024 lds
    buffer_load_dwordx4 v22, s[32:35], s56 offen offset:2048 lds
    s_add_u32 m0, s89, 84992
    s_nop 0
    buffer_load_dwordx4 v20, s[32:35], s87 offen lds
    buffer_load_dwordx4 v21, s[32:35], s87 offen offset:1024 lds
    buffer_load_dwordx4 v22, s[32:35], s87 offen offset:2048 lds
    s_waitcnt vmcnt(9)
    v_add_f32 v32, v32, v34
    v_add_f32 v33, v33, v35
    s_waitcnt vmcnt(8)
    v_add_f32 v36, v36, v38
    v_add_f32 v37, v37, v39
    s_waitcnt vmcnt(7)
    v_add_f32 v40, v40, v42
    v_add_f32 v41, v41, v43
    s_waitcnt vmcnt(6)
    v_add_f32 v44, v44, v46
    v_add_f32 v45, v45, v47
    v_add_f32 v32, v32, v36
    v_add_f32 v33, v33, v37
    v_add_f32 v40, v40, v44
    v_add_f32 v41, v41, v45
    v_add_f32 v32, v32, v40
    v_add_f32 v33, v33, v41
    v_mov_b32 v34, v32
    v_mov_b32 v35, v33
    s_nop 0
    v_permlane32_swap_b32 v32, v34
    v_permlane32_swap_b32 v33, v35
    v_add_f32 v32, v32, v34
    v_add_f32 v33, v33, v35
    v_mul_f32 v32, 0x3b000000, v32
    v_mul_f32 v33, 0x3b000000, v33
    v_fma_f32 v33, -v32, v32, v33
    v_max_f32 v33, 0, v33
    v_add_f32 v33, 0x3727c5ac, v33
    v_rcp_f32 v33, v33
    v_sub_f32 v32, 0, v32
    s_lshl_b32 s55, s44, 8
    s_add_u32 s55, s55, 156672
    v_and_b32 v2, 31, v0
    v_lshlrev_b32 v2, 3, v2
    v_add_u32 v2, s55, v2
    ds_write_b64 v2, v[32:33]
    s_waitcnt lgkmcnt(0)
    s_barrier
    s_xor_b32 s56, s88, 5
    s_lshl_b32 s56, s56, 12
    s_add_u32 s56, s56, s91
    s_lshl_b32 s87, s44, 12
    s_add_u32 m0, s87, 0
    s_nop 0
    buffer_load_dwordx4 v11, s[8:11], s56 offen sc1 lds
    buffer_load_dwordx4 v11, s[8:11], s56 offen offset:1024 sc1 lds
    buffer_load_dwordx4 v11, s[8:11], s56 offen offset:2048 sc1 lds
    buffer_load_dwordx4 v11, s[8:11], s56 offen offset:3072 sc1 lds
    s_xor_b32 s56, s88, 3
    s_mul_i32 s56, s56, 176128
    s_add_u32 s56, s56, s90
    s_add_u32 m0, s89, 106496
    s_add_u32 s87, s56, 44032
    buffer_load_dwordx4 v20, s[32:35], s56 offen lds
    buffer_load_dwordx4 v21, s[32:35], s56 offen offset:1024 lds
    buffer_load_dwordx4 v22, s[32:35], s56 offen offset:2048 lds
    s_add_u32 m0, s89, 109568
    s_nop 0
    buffer_load_dwordx4 v20, s[32:35], s87 offen lds
    buffer_load_dwordx4 v21, s[32:35], s87 offen offset:1024 lds
    buffer_load_dwordx4 v22, s[32:35], s87 offen offset:2048 lds
    s_waitcnt vmcnt(10)
    s_barrier
    s_xor_b32 s56, s88, 2
    s_lshl_b32 s56, s56, 12
    s_add_u32 s56, s56, s91
    s_lshl_b32 s87, s44, 12
    s_add_u32 m0, s87, 16384
    s_nop 0
    buffer_load_dwordx4 v11, s[8:11], s56 offen sc1 lds
    buffer_load_dwordx4 v11, s[8:11], s56 offen offset:1024 sc1 lds
    buffer_load_dwordx4 v11, s[8:11], s56 offen offset:2048 sc1 lds
    buffer_load_dwordx4 v11, s[8:11], s56 offen offset:3072 sc1 lds
    s_xor_b32 s56, s88, 6
    s_mul_i32 s56, s56, 176128
    s_add_u32 s56, s56, s90
    s_add_u32 m0, s89, 131072
    s_add_u32 s87, s56, 44032
    buffer_load_dwordx4 v20, s[32:35], s56 offen lds
    buffer_load_dwordx4 v21, s[32:35], s56 offen offset:1024 lds
    buffer_load_dwordx4 v22, s[32:35], s56 offen offset:2048 lds
    s_add_u32 m0, s89, 134144
    s_nop 0
    buffer_load_dwordx4 v20, s[32:35], s87 offen lds
    buffer_load_dwordx4 v21, s[32:35], s87 offen offset:1024 lds
    buffer_load_dwordx4 v22, s[32:35], s87 offen offset:2048 lds
    s_waitcnt vmcnt(16)
    s_waitcnt vmcnt(10)
    s_barrier
    s_xor_b32 s56, s88, 3
    s_lshl_b32 s56, s56, 12
    s_add_u32 s56, s56, s91
    s_lshl_b32 s87, s44, 12
    s_add_u32 m0, s87, 32768
    s_nop 0
    buffer_load_dwordx4 v11, s[8:11], s56 offen sc1 lds
    buffer_load_dwordx4 v11, s[8:11], s56 offen offset:1024 sc1 lds
    buffer_load_dwordx4 v11, s[8:11], s56 offen offset:2048 sc1 lds
    buffer_load_dwordx4 v11, s[8:11], s56 offen offset:3072 sc1 lds
    s_xor_b32 s56, s88, 7
    s_mul_i32 s56, s56, 176128
    s_add_u32 s56, s56, s90
    s_add_u32 m0, s89, 81920
    s_add_u32 s87, s56, 44032
    buffer_load_dwordx4 v20, s[32:35], s56 offen lds
    buffer_load_dwordx4 v21, s[32:35], s56 offen offset:1024 lds
    buffer_load_dwordx4 v22, s[32:35], s56 offen offset:2048 lds
    s_add_u32 m0, s89, 84992
    s_nop 0
    buffer_load_dwordx4 v20, s[32:35], s87 offen lds
    buffer_load_dwordx4 v21, s[32:35], s87 offen offset:1024 lds
    buffer_load_dwordx4 v22, s[32:35], s87 offen offset:2048 lds
    s_waitcnt vmcnt(16)
    s_waitcnt vmcnt(10)
    s_barrier
    s_xor_b32 s56, s88, 6
    s_lshl_b32 s56, s56, 12
    s_add_u32 s56, s56, s91
    s_lshl_b32 s87, s44, 12
    s_add_u32 m0, s87, 0
    s_nop 0
    buffer_load_dwordx4 v11, s[8:11], s56 offen sc1 lds
    buffer_load_dwordx4 v11, s[8:11], s56 offen offset:1024 sc1 lds
    buffer_load_dwordx4 v11, s[8:11], s56 offen offset:2048 sc1 lds
    buffer_load_dwordx4 v11, s[8:11], s56 offen offset:3072 sc1 lds
    s_lshl_b32 s56, s64, 4
    s_add_u32 m0, s92, 0
    s_add_u32 s87, s56, 7168
    buffer_load_dwordx4 v23, s[16:19], s56 offen lds
    buffer_load_dwordx4 v23, s[16:19], s87 offen offset:1024 lds
    s_lshl_b32 s56, s65, 4
    s_add_u32 m0, s92, 2048
    s_add_u32 s87, s56, 7168
    buffer_load_dwordx4 v23, s[16:19], s56 offen lds
    buffer_load_dwordx4 v23, s[16:19], s87 offen offset:1024 lds
    s_lshl_b32 s56, s66, 4
    s_add_u32 m0, s92, 4096
    s_add_u32 s87, s56, 7168
    buffer_load_dwordx4 v23, s[16:19], s56 offen lds
    buffer_load_dwordx4 v23, s[16:19], s87 offen offset:1024 lds
    s_lshl_b32 s56, s67, 4
    s_add_u32 m0, s92, 6144
    s_add_u32 s87, s56, 7168
    buffer_load_dwordx4 v23, s[16:19], s56 offen lds
    buffer_load_dwordx4 v23, s[16:19], s87 offen offset:1024 lds
    s_waitcnt vmcnt(18)
    s_waitcnt vmcnt(12)
    s_barrier
    s_xor_b32 s56, s88, 7
    s_lshl_b32 s56, s56, 12
    s_add_u32 s56, s56, s91
    s_lshl_b32 s87, s44, 12
    s_add_u32 m0, s87, 16384
    s_nop 0
    buffer_load_dwordx4 v11, s[8:11], s56 offen sc1 lds
    buffer_load_dwordx4 v11, s[8:11], s56 offen offset:1024 sc1 lds
    buffer_load_dwordx4 v11, s[8:11], s56 offen offset:2048 sc1 lds
    buffer_load_dwordx4 v11, s[8:11], s56 offen offset:3072 sc1 lds
    s_waitcnt vmcnt(12)
    s_barrier
    s_waitcnt vmcnt(10)
    ds_read_b64_tr_b16 v[80:81], v24 offset:0
    ds_read_b64_tr_b16 v[82:83], v24 offset:1024
    ds_read_b64_tr_b16 v[84:85], v25 offset:0
    ds_read_b64_tr_b16 v[86:87], v25 offset:1024
    s_waitcnt vmcnt(8)
    ds_read_b64_tr_b16 v[88:89], v24 offset:2048
    ds_read_b64_tr_b16 v[90:91], v24 offset:3072
    ds_read_b64_tr_b16 v[92:93], v25 offset:2048
    ds_read_b64_tr_b16 v[94:95], v25 offset:3072
    s_waitcnt vmcnt(6)
    ds_read_b64_tr_b16 v[96:97], v24 offset:4096
    ds_read_b64_tr_b16 v[98:99], v24 offset:5120
    ds_read_b64_tr_b16 v[100:101], v25 offset:4096
    ds_read_b64_tr_b16 v[102:103], v25 offset:5120
    s_waitcnt vmcnt(4)
    ds_read_b64_tr_b16 v[104:105], v24 offset:6144
    ds_read_b64_tr_b16 v[106:107], v24 offset:7168
    ds_read_b64_tr_b16 v[108:109], v25 offset:6144
    ds_read_b64_tr_b16 v[110:111], v25 offset:7168
    s_waitcnt lgkmcnt(0)
    s_lshl_b32 s56, s68, 4
    s_add_u32 m0, s92, 0
    s_add_u32 s87, s56, 7168
    buffer_load_dwordx4 v23, s[16:19], s56 offen lds
    buffer_load_dwordx4 v23, s[16:19], s87 offen offset:1024 lds
    s_lshl_b32 s56, s69, 4
    s_add_u32 m0, s92, 2048
    s_add_u32 s87, s56, 7168
    buffer_load_dwordx4 v23, s[16:19], s56 offen lds
    buffer_load_dwordx4 v23, s[16:19], s87 offen offset:1024 lds
    s_lshl_b32 s56, s70, 4
    s_add_u32 m0, s92, 4096
    s_add_u32 s87, s56, 7168
    buffer_load_dwordx4 v23, s[16:19], s56 offen lds
    buffer_load_dwordx4 v23, s[16:19], s87 offen offset:1024 lds
    s_lshl_b32 s56, s71, 4
    s_add_u32 m0, s92, 6144
    s_add_u32 s87, s56, 7168
    buffer_load_dwordx4 v23, s[16:19], s56 offen lds
    buffer_load_dwordx4 v23, s[16:19], s87 offen offset:1024 lds
    s_waitcnt vmcnt(8)
    s_barrier
    s_waitcnt vmcnt(6)
    ds_read_b64_tr_b16 v[112:113], v24 offset:0
    ds_read_b64_tr_b16 v[114:115], v24 offset:1024
    ds_read_b64_tr_b16 v[116:117], v25 offset:0
    ds_read_b64_tr_b16 v[118:119], v25 offset:1024
    s_waitcnt vmcnt(4)
    ds_read_b64_tr_b16 v[120:121], v24 offset:2048
    ds_read_b64_tr_b16 v[122:123], v24 offset:3072
    ds_read_b64_tr_b16 v[124:125], v25 offset:2048
    ds_read_b64_tr_b16 v[126:127], v25 offset:3072
    s_waitcnt vmcnt(2)
    ds_read_b64_tr_b16 v[128:129], v24 offset:4096
    ds_read_b64_tr_b16 v[130:131], v24 offset:5120
    ds_read_b64_tr_b16 v[132:133], v25 offset:4096
    ds_read_b64_tr_b16 v[134:135], v25 offset:5120
    s_waitcnt vmcnt(0)
    ds_read_b64_tr_b16 v[136:137], v24 offset:6144
    ds_read_b64_tr_b16 v[138:139], v24 offset:7168
    ds_read_b64_tr_b16 v[140:141], v25 offset:6144
    ds_read_b64_tr_b16 v[142:143], v25 offset:7168
    s_waitcnt lgkmcnt(0)
    s_lshl_b32 s56, s72, 4
    s_add_u32 m0, s92, 0
    s_add_u32 s87, s56, 7168
    buffer_load_dwordx4 v23, s[16:19], s56 offen lds
    buffer_load_dwordx4 v23, s[16:19], s87 offen offset:1024 lds
    s_lshl_b32 s56, s73, 4
    s_add_u32 m0, s92, 2048
    s_add_u32 s87, s56, 7168
    buffer_load_dwordx4 v23, s[16:19], s56 offen lds
    buffer_load_dwordx4 v23, s[16:19], s87 offen offset:1024 lds
    s_lshl_b32 s56, s74, 4
    s_add_u32 m0, s92, 4096
    s_add_u32 s87, s56, 7168
    buffer_load_dwordx4 v23, s[16:19], s56 offen lds
    buffer_load_dwordx4 v23, s[16:19], s87 offen offset:1024 lds
    s_lshl_b32 s56, s75, 4
    s_add_u32 m0, s92, 6144
    s_add_u32 s87, s56, 7168
    buffer_load_dwordx4 v23, s[16:19], s56 offen lds
    buffer_load_dwordx4 v23, s[16:19], s87 offen offset:1024 lds
    s_waitcnt vmcnt(6)
    ds_read_b64_tr_b16 v[144:145], v24 offset:0
    ds_read_b64_tr_b16 v[146:147], v24 offset:1024
    ds_read_b64_tr_b16 v[148:149], v25 offset:0
    ds_read_b64_tr_b16 v[150:151], v25 offset:1024
    s_waitcnt vmcnt(4)
    ds_read_b64_tr_b16 v[152:153], v24 offset:2048
    ds_read_b64_tr_b16 v[154:155], v24 offset:3072
    ds_read_b64_tr_b16 v[156:157], v25 offset:2048
    ds_read_b64_tr_b16 v[158:159], v25 offset:3072
    s_waitcnt vmcnt(2)
    ds_read_b64_tr_b16 v[160:161], v24 offset:4096
    ds_read_b64_tr_b16 v[162:163], v24 offset:5120
    ds_read_b64_tr_b16 v[164:165], v25 offset:4096
    ds_read_b64_tr_b16 v[166:167], v25 offset:5120
    s_waitcnt vmcnt(0)
    ds_read_b64_tr_b16 v[168:169], v24 offset:6144
    ds_read_b64_tr_b16 v[170:171], v24 offset:7168
    ds_read_b64_tr_b16 v[172:173], v25 offset:6144
    ds_read_b64_tr_b16 v[174:175], v25 offset:7168
    s_waitcnt lgkmcnt(0)
    s_lshl_b32 s56, s76, 4
    s_add_u32 m0, s92, 0
    s_add_u32 s87, s56, 7168
    buffer_load_dwordx4 v23, s[16:19], s56 offen lds
    buffer_load_dwordx4 v23, s[16:19], s87 offen offset:1024 lds
    s_lshl_b32 s56, s77, 4
    s_add_u32 m0, s92, 2048
    s_add_u32 s87, s56, 7168
    buffer_load_dwordx4 v23, s[16:19], s56 offen lds
    buffer_load_dwordx4 v23, s[16:19], s87 offen offset:1024 lds
    s_lshl_b32 s56, s78, 4
    s_add_u32 m0, s92, 4096
    s_add_u32 s87, s56, 7168
    buffer_load_dwordx4 v23, s[16:19], s56 offen lds
    buffer_load_dwordx4 v23, s[16:19], s87 offen offset:1024 lds
    s_lshl_b32 s56, s79, 4
    s_add_u32 m0, s92, 6144
    s_add_u32 s87, s56, 7168
    buffer_load_dwordx4 v23, s[16:19], s56 offen lds
    buffer_load_dwordx4 v23, s[16:19], s87 offen offset:1024 lds
    s_waitcnt vmcnt(6)
    ds_read_b64_tr_b16 v[176:177], v24 offset:0
    ds_read_b64_tr_b16 v[178:179], v24 offset:1024
    ds_read_b64_tr_b16 v[180:181], v25 offset:0
    ds_read_b64_tr_b16 v[182:183], v25 offset:1024
    s_waitcnt vmcnt(4)
    ds_read_b64_tr_b16 v[184:185], v24 offset:2048
    ds_read_b64_tr_b16 v[186:187], v24 offset:3072
    ds_read_b64_tr_b16 v[188:189], v25 offset:2048
    ds_read_b64_tr_b16 v[190:191], v25 offset:3072
    s_waitcnt vmcnt(2)
    ds_read_b64_tr_b16 v[192:193], v24 offset:4096
    ds_read_b64_tr_b16 v[194:195], v24 offset:5120
    ds_read_b64_tr_b16 v[196:197], v25 offset:4096
    ds_read_b64_tr_b16 v[198:199], v25 offset:5120
    s_waitcnt vmcnt(0)
    ds_read_b64_tr_b16 v[200:201], v24 offset:6144
    ds_read_b64_tr_b16 v[202:203], v24 offset:7168
    ds_read_b64_tr_b16 v[204:205], v25 offset:6144
    ds_read_b64_tr_b16 v[206:207], v25 offset:7168
    s_waitcnt lgkmcnt(0)
    s_lshl_b32 s56, s80, 4
    s_add_u32 m0, s92, 0
    s_add_u32 s87, s56, 7168
    buffer_load_dwordx4 v23, s[16:19], s56 offen lds
    buffer_load_dwordx4 v23, s[16:19], s87 offen offset:1024 lds
    s_lshl_b32 s56, s81, 4
    s_add_u32 m0, s92, 2048
    s_add_u32 s87, s56, 7168
    buffer_load_dwordx4 v23, s[16:19], s56 offen lds
    buffer_load_dwordx4 v23, s[16:19], s87 offen offset:1024 lds
    s_lshl_b32 s56, s82, 4
    s_add_u32 m0, s92, 4096
    s_add_u32 s87, s56, 7168
    buffer_load_dwordx4 v23, s[16:19], s56 offen lds
    buffer_load_dwordx4 v23, s[16:19], s87 offen offset:1024 lds
    s_lshl_b32 s56, s83, 4
    s_add_u32 m0, s92, 6144
    s_add_u32 s87, s56, 7168
    buffer_load_dwordx4 v23, s[16:19], s56 offen lds
    buffer_load_dwordx4 v23, s[16:19], s87 offen offset:1024 lds
    s_waitcnt vmcnt(6)
    ds_read_b64_tr_b16 v[208:209], v24 offset:0
    ds_read_b64_tr_b16 v[210:211], v24 offset:1024
    ds_read_b64_tr_b16 v[212:213], v25 offset:0
    ds_read_b64_tr_b16 v[214:215], v25 offset:1024
    s_waitcnt vmcnt(4)
    ds_read_b64_tr_b16 v[216:217], v24 offset:2048
    ds_read_b64_tr_b16 v[218:219], v24 offset:3072
    ds_read_b64_tr_b16 v[220:221], v25 offset:2048
    ds_read_b64_tr_b16 v[222:223], v25 offset:3072
    s_waitcnt vmcnt(2)
    ds_read_b64_tr_b16 v[224:225], v24 offset:4096
    ds_read_b64_tr_b16 v[226:227], v24 offset:5120
    ds_read_b64_tr_b16 v[228:229], v25 offset:4096
    ds_read_b64_tr_b16 v[230:231], v25 offset:5120
    s_waitcnt vmcnt(0)
    ds_read_b64_tr_b16 v[232:233], v24 offset:6144
    ds_read_b64_tr_b16 v[234:235], v24 offset:7168
    ds_read_b64_tr_b16 v[236:237], v25 offset:6144
    ds_read_b64_tr_b16 v[238:239], v25 offset:7168
    s_waitcnt lgkmcnt(0)
    s_lshl_b32 s56, s84, 4
    s_add_u32 m0, s92, 0
    s_add_u32 s87, s56, 7168
    buffer_load_dwordx4 v23, s[16:19], s56 offen lds
    buffer_load_dwordx4 v23, s[16:19], s87 offen offset:1024 lds
    s_lshl_b32 s56, s85, 4
    s_add_u32 m0, s92, 2048
    s_add_u32 s87, s56, 7168
    buffer_load_dwordx4 v23, s[16:19], s56 offen lds
    buffer_load_dwordx4 v23, s[16:19], s87 offen offset:1024 lds
    s_waitcnt vmcnt(2)
    ds_read_b64_tr_b16 v[240:241], v24 offset:0
    ds_read_b64_tr_b16 v[242:243], v24 offset:1024
    ds_read_b64_tr_b16 v[244:245], v25 offset:0
    ds_read_b64_tr_b16 v[246:247], v25 offset:1024
    s_waitcnt vmcnt(0)
    ds_read_b64_tr_b16 v[248:249], v24 offset:2048
    ds_read_b64_tr_b16 v[250:251], v24 offset:3072
    ds_read_b64_tr_b16 v[252:253], v25 offset:2048
    ds_read_b64_tr_b16 v[254:255], v25 offset:3072
    s_waitcnt lgkmcnt(0)
    s_mul_i32 s50, s44, 24576
    s_add_u32 s50, s50, 49152
    v_add_u32 v12, s50, v11
    s_barrier
    s_barrier
    ds_read_b128 v[64:67], v12 offset:0
    ds_read_b128 v[68:71], v12 offset:1024
    ds_read_b128 v[72:75], v12 offset:2048
    s_waitcnt lgkmcnt(2)
    v_mfma_f32_32x32x16_bf16 v[16:31], v[80:83], v[64:67], 0
    ds_read_b128 v[76:79], v12 offset:3072
    v_mfma_f32_32x32x16_bf16 v[32:47], v[84:87], v[64:67], 0
    s_barrier
    ds_read_b128 v[64:67], v12 offset:4096
    s_waitcnt lgkmcnt(3)
    v_mfma_f32_32x32x16_bf16 v[16:31], v[88:91], v[68:71], v[16:31]
    v_mfma_f32_32x32x16_bf16 v[32:47], v[92:95], v[68:71], v[32:47]
    ds_read_b128 v[68:71], v12 offset:5120
    s_waitcnt lgkmcnt(3)
    v_mfma_f32_32x32x16_bf16 v[16:31], v[96:99], v[72:75], v[16:31]
    v_mfma_f32_32x32x16_bf16 v[32:47], v[100:103], v[72:75], v[32:47]
    ds_read_b128 v[72:75], v12 offset:6144
    s_waitcnt lgkmcnt(3)
    v_mfma_f32_32x32x16_bf16 v[16:31], v[104:107], v[76:79], v[16:31]
    v_mfma_f32_32x32x16_bf16 v[32:47], v[108:111], v[76:79], v[32:47]
    ds_read_b128 v[76:79], v12 offset:7168
    s_waitcnt lgkmcnt(3)
    v_mfma_f32_32x32x16_bf16 v[16:31], v[112:115], v[64:67], v[16:31]
    v_mfma_f32_32x32x16_bf16 v[32:47], v[116:119], v[64:67], v[32:47]
    s_barrier
    ds_read_b128 v[64:67], v12 offset:8192
    s_waitcnt lgkmcnt(3)
    v_mfma_f32_32x32x16_bf16 v[16:31], v[120:123], v[68:71], v[16:31]
    v_mfma_f32_32x32x16_bf16 v[32:47], v[124:127], v[68:71], v[32:47]
    ds_read_b128 v[68:71], v12 offset:9216
    s_waitcnt lgkmcnt(3)
    v_mfma_f32_32x32x16_bf16 v[16:31], v[128:131], v[72:75], v[16:31]
    v_mfma_f32_32x32x16_bf16 v[32:47], v[132:135], v[72:75], v[32:47]
    ds_read_b128 v[72:75], v12 offset:10240
    s_waitcnt lgkmcnt(3)
    v_mfma_f32_32x32x16_bf16 v[16:31], v[136:139], v[76:79], v[16:31]
    v_mfma_f32_32x32x16_bf16 v[32:47], v[140:143], v[76:79], v[32:47]
    ds_read_b128 v[76:79], v12 offset:11264
    s_waitcnt lgkmcnt(3)
    v_mfma_f32_32x32x16_bf16 v[16:31], v[144:147], v[64:67], v[16:31]
    v_mfma_f32_32x32x16_bf16 v[32:47], v[148:151], v[64:67], v[32:47]
    s_barrier
    ds_read_b128 v[64:67], v12 offset:12288
    s_waitcnt lgkmcnt(3)
    v_mfma_f32_32x32x16_bf16 v[16:31], v[152:155], v[68:71], v[16:31]
    v_mfma_f32_32x32x16_bf16 v[32:47], v[156:159], v[68:71], v[32:47]
    ds_read_b128 v[68:71], v12 offset:13312
    s_waitcnt lgkmcnt(3)
    v_mfma_f32_32x32x16_bf16 v[16:31], v[160:163], v[72:75], v[16:31]
    v_mfma_f32_32x32x16_bf16 v[32:47], v[164:167], v[72:75], v[32:47]
    ds_read_b128 v[72:75], v12 offset:14336
    s_waitcnt lgkmcnt(3)
    v_mfma_f32_32x32x16_bf16 v[16:31], v[168:171], v[76:79], v[16:31]
    v_mfma_f32_32x32x16_bf16 v[32:47], v[172:175], v[76:79], v[32:47]
    ds_read_b128 v[76:79], v12 offset:15360
    s_waitcnt lgkmcnt(3)
    v_mfma_f32_32x32x16_bf16 v[16:31], v[176:179], v[64:67], v[16:31]
    v_mfma_f32_32x32x16_bf16 v[32:47], v[180:183], v[64:67], v[32:47]
    s_barrier
    ds_read_b128 v[64:67], v12 offset:16384
    s_waitcnt lgkmcnt(3)
    v_mfma_f32_32x32x16_bf16 v[16:31], v[184:187], v[68:71], v[16:31]
    v_mfma_f32_32x32x16_bf16 v[32:47], v[188:191], v[68:71], v[32:47]
    ds_read_b128 v[68:71], v12 offset:17408
    s_waitcnt lgkmcnt(3)
    v_mfma_f32_32x32x16_bf16 v[16:31], v[192:195], v[72:75], v[16:31]
    v_mfma_f32_32x32x16_bf16 v[32:47], v[196:199], v[72:75], v[32:47]
    ds_read_b128 v[72:75], v12 offset:18432
    s_waitcnt lgkmcnt(3)
    v_mfma_f32_32x32x16_bf16 v[16:31], v[200:203], v[76:79], v[16:31]
    v_mfma_f32_32x32x16_bf16 v[32:47], v[204:207], v[76:79], v[32:47]
    ds_read_b128 v[76:79], v12 offset:19456
    s_waitcnt lgkmcnt(3)
    v_mfma_f32_32x32x16_bf16 v[16:31], v[208:211], v[64:67], v[16:31]
    v_mfma_f32_32x32x16_bf16 v[32:47], v[212:215], v[64:67], v[32:47]
    s_barrier
    ds_read_b128 v[64:67], v12 offset:20480
    s_waitcnt lgkmcnt(3)
    v_mfma_f32_32x32x16_bf16 v[16:31], v[216:219], v[68:71], v[16:31]
    v_mfma_f32_32x32x16_bf16 v[32:47], v[220:223], v[68:71], v[32:47]
    ds_read_b128 v[68:71], v12 offset:21504
    s_waitcnt lgkmcnt(3)
    v_mfma_f32_32x32x16_bf16 v[16:31], v[224:227], v[72:75], v[16:31]
    v_mfma_f32_32x32x16_bf16 v[32:47], v[228:231], v[72:75], v[32:47]
    ds_read_b128 v[72:75], v12 offset:22528
    s_waitcnt lgkmcnt(3)
    v_mfma_f32_32x32x16_bf16 v[16:31], v[232:235], v[76:79], v[16:31]
    v_mfma_f32_32x32x16_bf16 v[32:47], v[236:239], v[76:79], v[32:47]
    ds_read_b128 v[76:79], v12 offset:23552
    s_waitcnt lgkmcnt(3)
    v_mfma_f32_32x32x16_bf16 v[16:31], v[240:243], v[64:67], v[16:31]
    v_mfma_f32_32x32x16_bf16 v[32:47], v[244:247], v[64:67], v[32:47]
    s_barrier
    ds_read_b128 v[64:67], v12 offset:0
    s_waitcnt lgkmcnt(3)
    v_mfma_f32_32x32x16_bf16 v[16:31], v[248:251], v[68:71], v[16:31]
    v_mfma_f32_32x32x16_bf16 v[32:47], v[252:255], v[68:71], v[32:47]
    ds_read_b128 v[68:71], v12 offset:1024
    s_waitcnt lgkmcnt(3)
    v_mfma_f32_32x32x16_bf16 v[48:63], v[80:83], v[72:75], 0
    ds_read_b128 v[72:75], v12 offset:2048
    s_xor_b32 s55, s44, 3
    s_mul_i32 s55, s55, 12288
    v_add_u32 v10, s55, v11
    s_nop 3
    ds_write_b128 v10, v[16:19] offset:0
    s_waitcnt lgkmcnt(4)
    v_mfma_f32_32x32x16_bf16 v[48:63], v[88:91], v[76:79], v[48:63]
    ds_read_b128 v[76:79], v12 offset:3072
    ds_write_b128 v10, v[20:23] offset:1024
    s_waitcnt lgkmcnt(5)
    v_mfma_f32_32x32x16_bf16 v[48:63], v[96:99], v[64:67], v[48:63]
    s_barrier
    ds_read_b128 v[64:67], v12 offset:4096
    ds_write_b128 v10, v[24:27] offset:2048
    s_waitcnt lgkmcnt(6)
    v_mfma_f32_32x32x16_bf16 v[48:63], v[104:107], v[68:71], v[48:63]
    ds_read_b128 v[68:71], v12 offset:22528
    ds_write_b128 v10, v[28:31] offset:3072
    s_waitcnt lgkmcnt(7)
    v_mfma_f32_32x32x16_bf16 v[48:63], v[112:115], v[72:75], v[48:63]
    ds_read_b128 v[72:75], v12 offset:5120
    s_waitcnt lgkmcnt(6)
    v_mfma_f32_32x32x16_bf16 v[48:63], v[120:123], v[76:79], v[48:63]
    ds_read_b128 v[76:79], v12 offset:23552
    s_waitcnt lgkmcnt(5)
    v_mfma_f32_32x32x16_bf16 v[48:63], v[128:131], v[64:67], v[48:63]
    s_waitcnt lgkmcnt(2)
    v_mfma_f32_32x32x16_bf16 v[16:31], v[132:135], v[64:67], 0
    ds_read_b128 v[64:67], v12 offset:6144
    v_mfma_f32_32x32x16_bf16 v[16:31], v[84:87], v[68:71], v[16:31]
    ds_read_b128 v[68:71], v12 offset:0
    s_xor_b32 s55, s44, 2
    s_mul_i32 s55, s55, 12288
    v_add_u32 v10, s55, v11
    s_waitcnt lgkmcnt(3)
    v_mfma_f32_32x32x16_bf16 v[48:63], v[136:139], v[72:75], v[48:63]
    v_mfma_f32_32x32x16_bf16 v[16:31], v[140:143], v[72:75], v[16:31]
    ds_read_b128 v[72:75], v12 offset:7168
    ds_write_b128 v10, v[32:35] offset:4096
    s_waitcnt lgkmcnt(4)
    v_mfma_f32_32x32x16_bf16 v[16:31], v[92:95], v[76:79], v[16:31]
    ds_read_b128 v[76:79], v12 offset:1024
    s_waitcnt lgkmcnt(4)
    v_mfma_f32_32x32x16_bf16 v[48:63], v[144:147], v[64:67], v[48:63]
    ds_write_b128 v10, v[36:39] offset:5120
    v_mfma_f32_32x32x16_bf16 v[16:31], v[148:151], v[64:67], v[16:31]
    s_barrier
    ds_read_b128 v[64:67], v12 offset:8192
    s_waitcnt lgkmcnt(5)
    v_mfma_f32_32x32x16_bf16 v[16:31], v[100:103], v[68:71], v[16:31]
    ds_read_b128 v[68:71], v12 offset:2048
    ds_write_b128 v10, v[40:43] offset:6144
    s_waitcnt lgkmcnt(6)
    v_mfma_f32_32x32x16_bf16 v[48:63], v[152:155], v[72:75], v[48:63]
    v_mfma_f32_32x32x16_bf16 v[16:31], v[156:159], v[72:75], v[16:31]
    ds_read_b128 v[72:75], v12 offset:9216
    ds_write_b128 v10, v[44:47] offset:7168
    s_waitcnt lgkmcnt(6)
    v_mfma_f32_32x32x16_bf16 v[16:31], v[108:111], v[76:79], v[16:31]
    ds_read_b128 v[76:79], v12 offset:3072
    s_waitcnt lgkmcnt(5)
    v_mfma_f32_32x32x16_bf16 v[48:63], v[160:163], v[64:67], v[48:63]
    v_mfma_f32_32x32x16_bf16 v[16:31], v[164:167], v[64:67], v[16:31]
    ds_read_b128 v[64:67], v12 offset:10240
    s_waitcnt lgkmcnt(5)
    v_mfma_f32_32x32x16_bf16 v[16:31], v[116:119], v[68:71], v[16:31]
    ds_read_b128 v[68:71], v12 offset:11264
    s_waitcnt lgkmcnt(4)
    v_mfma_f32_32x32x16_bf16 v[48:63], v[168:171], v[72:75], v[48:63]
    v_mfma_f32_32x32x16_bf16 v[16:31], v[172:175], v[72:75], v[16:31]
    s_barrier
    ds_read_b128 v[72:75], v12 offset:12288
    s_waitcnt lgkmcnt(3)
    v_mfma_f32_32x32x16_bf16 v[16:31], v[124:127], v[76:79], v[16:31]
    ds_read_b128 v[76:79], v12 offset:13312
    s_waitcnt lgkmcnt(3)
    v_mfma_f32_32x32x16_bf16 v[48:63], v[176:179], v[64:67], v[48:63]
    v_mfma_f32_32x32x16_bf16 v[16:31], v[180:183], v[64:67], v[16:31]
    ds_read_b128 v[64:67], v12 offset:14336
    buffer_load_dwordx4 v[128:131], v11, s[24:27], s93 offen sc1
    buffer_load_dwordx4 v[132:135], v11, s[24:27], s93 offen offset:1024 sc1
    s_waitcnt lgkmcnt(3)
    v_mfma_f32_32x32x16_bf16 v[48:63], v[184:187], v[68:71], v[48:63]
    v_mfma_f32_32x32x16_bf16 v[16:31], v[188:191], v[68:71], v[16:31]
    ds_read_b128 v[68:71], v12 offset:15360
    s_mul_i32 s55, s44, 12288
    v_add_u32 v10, s55, v11
    v_mov_b32 v2, 156656
    v_mov_b32 v3, 1
    s_mov_b64 exec, 1
    ds_add_u32 v2, v3
    s_mov_b64 exec, -1
    s_mov_b32 s57, 0
BS_red4a:
    ds_read_b32 v3, v2
    s_add_u32 s57, s57, 1
    s_waitcnt lgkmcnt(0)
    v_readfirstlane_b32 s55, v3
    s_cmp_ge_u32 s57, 0x100000
    s_cbranch_scc1 BS_red4a_D
    s_cmp_lt_u32 s55, 4
    s_cbranch_scc1 BS_red4a
BS_red4a_D:
    ds_read_b128 v[80:83], v10 offset:0
    ds_read_b128 v[84:87], v10 offset:1024
    ds_read_b128 v[88:91], v10 offset:2048
    ds_read_b128 v[92:95], v10 offset:3072
    ds_read_b128 v[96:99], v10 offset:4096
    ds_read_b128 v[100:103], v10 offset:5120
    ds_read_b128 v[104:107], v10 offset:6144
    ds_read_b128 v[108:111], v10 offset:7168
    v_mfma_f32_32x32x16_bf16 v[48:63], v[192:195], v[72:75], v[48:63]
    v_mfma_f32_32x32x16_bf16 v[16:31], v[196:199], v[72:75], v[16:31]
    s_barrier
    ds_read_b128 v[72:75], v12 offset:16384
    s_waitcnt lgkmcnt(4)
    v_add_f32 v80, v80, v96
    v_add_f32 v81, v81, v97
    v_add_f32 v82, v82, v98
    v_add_f32 v83, v83, v99
    v_mfma_f32_32x32x16_bf16 v[48:63], v[200:203], v[76:79], v[48:63]
    s_waitcnt lgkmcnt(3)
    v_add_f32 v84, v84, v100
    v_add_f32 v85, v85, v101
    v_add_f32 v86, v86, v102
    v_add_f32 v87, v87, v103
    v_mfma_f32_32x32x16_bf16 v[16:31], v[204:207], v[76:79], v[16:31]
    ds_read_b128 v[76:79], v12 offset:17408
    s_waitcnt lgkmcnt(3)
    v_add_f32 v88, v88, v104
    v_add_f32 v89, v89, v105
    v_add_f32 v90, v90, v106
    v_add_f32 v91, v91, v107
    v_mfma_f32_32x32x16_bf16 v[48:63], v[208:211], v[64:67], v[48:63]
    s_waitcnt lgkmcnt(2)
    v_add_f32 v92, v92, v108
    v_add_f32 v93, v93, v109
    v_add_f32 v94, v94, v110
    v_add_f32 v95, v95, v111
    v_mfma_f32_32x32x16_bf16 v[16:31], v[212:215], v[64:67], v[16:31]
    ds_read_b128 v[64:67], v12 offset:18432
    s_waitcnt vmcnt(1)
    v_lshlrev_b32 v96, 16, v128
    v_and_b32 v97, 0xffff0000, v128
    v_lshlrev_b32 v98, 16, v129
    v_and_b32 v99, 0xffff0000, v129
    v_mfma_f32_32x32x16_bf16 v[48:63], v[216:219], v[68:71], v[48:63]
    v_lshlrev_b32 v100, 16, v130
    v_and_b32 v101, 0xffff0000, v130
    v_lshlrev_b32 v102, 16, v131
    v_and_b32 v103, 0xffff0000, v131
    v_mfma_f32_32x32x16_bf16 v[16:31], v[220:223], v[68:71], v[16:31]
    ds_read_b128 v[68:71], v12 offset:19456
    s_waitcnt vmcnt(0)
    v_lshlrev_b32 v104, 16, v132
    v_and_b32 v105, 0xffff0000, v132
    v_lshlrev_b32 v106, 16, v133
    v_and_b32 v107, 0xffff0000, v133
    s_waitcnt lgkmcnt(3)
    v_mfma_f32_32x32x16_bf16 v[48:63], v[224:227], v[72:75], v[48:63]
    v_lshlrev_b32 v108, 16, v134
    v_and_b32 v109, 0xffff0000, v134
    v_lshlrev_b32 v110, 16, v135
    v_and_b32 v111, 0xffff0000, v135
    v_mfma_f32_32x32x16_bf16 v[16:31], v[228:231], v[72:75], v[16:31]
    v_add_f32 v80, v80, v96
    v_add_f32 v81, v81, v97
    v_add_f32 v82, v82, v98
    v_add_f32 v83, v83, v99
    s_waitcnt lgkmcnt(2)
    v_mfma_f32_32x32x16_bf16 v[48:63], v[232:235], v[76:79], v[48:63]
    v_add_f32 v84, v84, v100
    v_add_f32 v85, v85, v101
    v_add_f32 v86, v86, v102
    v_add_f32 v87, v87, v103
    s_waitcnt lgkmcnt(1)
    v_mfma_f32_32x32x16_bf16 v[48:63], v[240:243], v[64:67], v[48:63]
    v_add_f32 v88, v88, v104
    v_add_f32 v89, v89, v105
    v_add_f32 v90, v90, v106
    v_add_f32 v91, v91, v107
    s_waitcnt lgkmcnt(0)
    v_mfma_f32_32x32x16_bf16 v[48:63], v[248:251], v[68:71], v[48:63]
    v_add_f32 v92, v92, v108
    v_add_f32 v93, v93, v109
    v_add_f32 v94, v94, v110
    v_add_f32 v95, v95, v111
    v_mfma_f32_32x32x16_bf16 v[16:31], v[236:239], v[76:79], v[16:31]
    s_xor_b32 s55, s44, 1
    s_mul_i32 s55, s55, 12288
    v_add_u32 v10, s55, v11
    s_nop 3
    ds_write_b128 v10, v[48:51] offset:8192
    ds_write_b128 v10, v[52:55] offset:9216
    v_mfma_f32_32x32x16_bf16 v[16:31], v[244:247], v[64:67], v[16:31]
    ds_write_b128 v10, v[56:59] offset:10240
    ds_write_b128 v10, v[60:63] offset:11264
    v_mfma_f32_32x32x16_bf16 v[16:31], v[252:255], v[68:71], v[16:31]
    s_mul_i32 s55, s44, 12288
    v_add_u32 v10, s55, v11
    v_mov_b32 v2, 156652
    v_mov_b32 v3, 1
    s_mov_b64 exec, 1
    ds_add_u32 v2, v3
    s_mov_b64 exec, -1
    s_mov_b32 s57, 0
BS_red4:
    ds_read_b32 v3, v2
    s_add_u32 s57, s57, 1
    s_waitcnt lgkmcnt(0)
    v_readfirstlane_b32 s55, v3
    s_cmp_ge_u32 s57, 0x100000
    s_cbranch_scc1 BS_red4_D
    s_cmp_lt_u32 s55, 4
    s_cbranch_scc1 BS_red4
BS_red4_D:
    ds_read_b128 v[112:115], v10 offset:8192
    ds_read_b128 v[116:119], v10 offset:9216
    ds_read_b128 v[120:123], v10 offset:10240
    ds_read_b128 v[124:127], v10 offset:11264
    s_waitcnt lgkmcnt(3)
    v_pk_add_f32 v[80:81], v[80:81], v[112:113]
    v_pk_add_f32 v[82:83], v[82:83], v[114:115]
    s_waitcnt lgkmcnt(2)
    v_pk_add_f32 v[84:85], v[84:85], v[116:117]
    v_pk_add_f32 v[86:87], v[86:87], v[118:119]
    s_waitcnt lgkmcnt(1)
    v_pk_add_f32 v[88:89], v[88:89], v[120:121]
    v_pk_add_f32 v[90:91], v[90:91], v[122:123]
    s_waitcnt lgkmcnt(0)
    v_pk_add_f32 v[92:93], v[92:93], v[124:125]
    v_pk_add_f32 v[94:95], v[94:95], v[126:127]
    v_pk_add_f32 v[16:17], v[16:17], v[80:81]
    v_pk_add_f32 v[18:19], v[18:19], v[82:83]
    v_pk_add_f32 v[20:21], v[20:21], v[84:85]
    v_pk_add_f32 v[22:23], v[22:23], v[86:87]
    v_pk_add_f32 v[24:25], v[24:25], v[88:89]
    v_pk_add_f32 v[26:27], v[26:27], v[90:91]
    v_pk_add_f32 v[28:29], v[28:29], v[92:93]
    v_pk_add_f32 v[30:31], v[30:31], v[94:95]
    v_cvt_pk_bf16_f32 v136, v16, v17
    v_cvt_pk_bf16_f32 v137, v18, v19
    v_cvt_pk_bf16_f32 v138, v20, v21
    v_cvt_pk_bf16_f32 v139, v22, v23
    v_cvt_pk_bf16_f32 v140, v24, v25
    v_cvt_pk_bf16_f32 v141, v26, v27
    v_cvt_pk_bf16_f32 v142, v28, v29
    v_cvt_pk_bf16_f32 v143, v30, v31
    v_permlane16_swap_b32 v136, v140
    v_permlane16_swap_b32 v137, v141
    v_permlane16_swap_b32 v138, v142
    v_permlane16_swap_b32 v139, v143
    buffer_store_dwordx4 v[136:139], v1, s[20:23], 0 offen
    buffer_store_dwordx4 v[140:143], v1, s[20:23], 0 offen offset:1024
    s_endpgm
PROG_A:
    v_lshlrev_b32 v148, 4, v0
    s_mul_i32 s50, s43, 10
    s_mul_i32 s51, s44, 3
    s_add_u32 s50, s50, s51
    s_lshl_b32 s55, s46, 6
    s_mov_b32 s6, 2097152
    s_mov_b32 s7, 0x20000
    s_add_u32 s51, s50, 0
    s_min_u32 s51, s51, 79
    s_and_b32 s52, s51, 15
    s_lshr_b32 s53, s51, 5
    s_lshl_b32 s53, s53, 5
    s_lshl_b32 s54, s52, 1
    s_add_u32 s53, s53, s54
    s_bfe_u32 s54, s51, 65540
    s_add_u32 s53, s53, s54
    s_add_u32 s53, s53, s55
    s_add_u32 s52, s52, s55
    s_sub_i32 s52, s52, 16
    s_max_i32 s52, s52, 0
    s_cmp_ge_u32 s51, 64
    s_cselect_b32 s53, s52, s53
    s_lshl_b32 s60, s53, 10
    s_add_u32 s51, s50, 1
    s_min_u32 s51, s51, 79
    s_and_b32 s52, s51, 15
    s_lshr_b32 s53, s51, 5
    s_lshl_b32 s53, s53, 5
    s_lshl_b32 s54, s52, 1
    s_add_u32 s53, s53, s54
    s_bfe_u32 s54, s51, 65540
    s_add_u32 s53, s53, s54
    s_add_u32 s53, s53, s55
    s_add_u32 s52, s52, s55
    s_sub_i32 s52, s52, 16
    s_max_i32 s52, s52, 0
    s_cmp_ge_u32 s51, 64
    s_cselect_b32 s53, s52, s53
    s_lshl_b32 s61, s53, 10
    s_add_u32 s51, s50, 2
    s_min_u32 s51, s51, 79
    s_and_b32 s52, s51, 15
    s_lshr_b32 s53, s51, 5
    s_lshl_b32 s53, s53, 5
    s_lshl_b32 s54, s52, 1
    s_add_u32 s53, s53, s54
    s_bfe_u32 s54, s51, 65540
    s_add_u32 s53, s53, s54
    s_add_u32 s53, s53, s55
    s_add_u32 s52, s52, s55
    s_sub_i32 s52, s52, 16
    s_max_i32 s52, s52, 0
    s_cmp_ge_u32 s51, 64
    s_cselect_b32 s53, s52, s53
    s_lshl_b32 s62, s53, 10
    s_waitcnt lgkmcnt(0)
    s_mov_b32 s4, s64
    s_and_b32 s5, s65, 0xffff
    buffer_load_dwordx4 v[208:211], v148, s[4:7], s60 offen
    buffer_load_dwordx4 v[212:215], v148, s[4:7], s61 offen
    buffer_load_dwordx4 v[216:219], v148, s[4:7], s62 offen
    v_lshrrev_b32 v3, 4, v0
    v_and_b32 v1, 15, v0
    v_lshrrev_b32 v2, 1, v1
    v_xor_b32 v2, v2, v3
    v_lshlrev_b32 v2, 4, v2
    v_lshl_add_u32 v8, v1, 7, v2
    v_xor_b32 v9, 64, v8
    v_mul_u32_u24 v10, 3072, v3
    v_bfe_u32 v2, v0, 2, 2
    v_lshl_add_u32 v10, v2, 7, v10
    v_lshrrev_b32 v2, 1, v2
    v_and_b32 v4, 1, v3
    v_lshl_or_b32 v2, v4, 1, v2
    v_xor_b32 v2, s44, v2
    v_lshl_add_u32 v10, v2, 5, v10
    v_and_b32 v2, 3, v0
    v_lshl_add_u32 v10, v2, 3, v10
    v_add_u32 v10, 81920, v10
    v_lshlrev_b32 v11, 2, v1
    v_add_u32 v11, 155648, v11
    v_lshlrev_b32 v12, 4, v3
    v_add_u32 v12, 155648, v12
    v_lshrrev_b32 v2, 3, v0
    v_mul_u32_u24 v2, 10240, v2
    v_and_b32 v4, 7, v0
    v_lshl_add_u32 v2, v4, 4, v2
    v_mov_b32 v16, s48
    v_mov_b32 v17, s48
    v_mov_b32 v18, s48
    v_mov_b32 v19, s48
    ds_write_b128 v2, v[16:19] offset:8192
    v_mov_b32 v5, 0xf149f2ca
    v_lshlrev_b32 v2, 2, v3
    v_sub_u32 v4, v1, v2
    v_subrev_u32 v2, 0, v4
    v_cmp_ge_u32 vcc, 7, v2
    v_cmp_ge_i32 s[54:55], -9, v2
    s_nop 0
    v_cndmask_b32 v160, v5, 0, vcc
    v_cndmask_b32 v164, v5, 0, s[54:55]
    v_subrev_u32 v2, 1, v4
    v_cmp_ge_u32 vcc, 7, v2
    v_cmp_ge_i32 s[54:55], -9, v2
    s_nop 0
    v_cndmask_b32 v161, v5, 0, vcc
    v_cndmask_b32 v165, v5, 0, s[54:55]
    v_subrev_u32 v2, 2, v4
    v_cmp_ge_u32 vcc, 7, v2
    v_cmp_ge_i32 s[54:55], -9, v2
    s_nop 0
    v_cndmask_b32 v162, v5, 0, vcc
    v_cndmask_b32 v166, v5, 0, s[54:55]
    v_subrev_u32 v2, 3, v4
    v_cmp_ge_u32 vcc, 7, v2
    v_cmp_ge_i32 s[54:55], -9, v2
    s_nop 0
    v_cndmask_b32 v163, v5, 0, vcc
    v_cndmask_b32 v167, v5, 0, s[54:55]
    s_cmp_eq_u32 s46, 0
    s_cselect_b32 s50, 64, 2
    v_lshlrev_b32 v2, 2, v3
    v_lshlrev_b32 v4, 1, v1
    v_sub_u32 v4, v2, v4
    v_subrev_u32 v4, s50, v4
    v_cmp_le_i32 vcc, 0, v4
    v_cmp_le_i32 s[54:55], -2, v4
    v_mov_b32 v169, v5
    v_mov_b32 v171, v5
    v_mov_b32 v172, v5
    v_mov_b32 v174, v5
    v_cndmask_b32 v168, v5, 0, vcc
    v_cndmask_b32 v170, v5, 0, s[54:55]
    v_cndmask_b32 v173, v5, 0, vcc
    v_cndmask_b32 v175, v5, 0, s[54:55]
    s_waitcnt lgkmcnt(0)
    s_mul_i32 s50, s45, 655360
    s_add_u32 s24, s82, s50
    s_addc_u32 s25, s83, 0
    s_and_b32 s25, s25, 0xffff
    s_mov_b32 s26, 655360
    s_mov_b32 s27, 0x20000
    s_bitcmp1_b32 s44, 0
    s_cselect_b32 s32, s74, s72
    s_cselect_b32 s33, s75, s73
    s_and_b32 s33, s33, 0xffff
    s_cmp_eq_u32 s47, 15
    s_cselect_b32 s34, 0, 1409024
    s_mov_b32 s35, 0x20000
    s_mov_b32 s28, s80
    s_and_b32 s29, s81, 0xffff
    s_mov_b32 s30, 256
    s_mov_b32 s31, 0x20000
    s_and_b32 s93, s46, 1
    s_lshl_b32 s93, s93, 16
    s_lshl_b32 s51, s43, 12
    s_add_u32 s93, s93, s51
    s_lshl_b32 s51, s44, 10
    s_add_u32 s93, s93, s51
    s_add_u32 s93, s93, 4096
    s_add_u32 s94, s93, 32768
    v_and_b32 v13, 15, v0
    v_bfe_u32 v3, v0, 4, 1
    v_lshl_add_u32 v13, v3, 5, v13
    v_lshrrev_b32 v3, 5, v0
    v_lshl_add_u32 v13, v3, 4, v13
    v_lshlrev_b32 v13, 4, v13
    s_lshl_b32 s50, s45, 3
    v_mov_b32 v14, s50
    s_lshl_b32 s98, s42, 13
    s_lshl_b32 s99, s44, 10
    s_and_b32 s91, s46, 1
    s_lshl_b32 s91, s91, 16
    s_add_u32 s91, s91, 4096
    s_add_u32 s60, s98, 0
    s_and_b32 s60, s60, 32767
    s_add_u32 s60, s60, s99
    s_add_u32 s61, s98, 4096
    s_and_b32 s61, s61, 32767
    s_add_u32 s61, s61, s99
    s_add_u32 s62, s98, 8192
    s_and_b32 s62, s62, 32767
    s_add_u32 s62, s62, s99
    s_add_u32 s63, s98, 12288
    s_and_b32 s63, s63, 32767
    s_add_u32 s63, s63, s99
    s_add_u32 s86, s98, 16384
    s_and_b32 s86, s86, 32767
    s_add_u32 s86, s86, s99
    s_add_u32 s58, s98, 20480
    s_and_b32 s58, s58, 32767
    s_add_u32 s58, s58, s99
    s_add_u32 s59, s98, 24576
    s_and_b32 s59, s59, 32767
    s_add_u32 s59, s59, s99
    s_add_u32 s101, s98, 28672
    s_and_b32 s101, s101, 32767
    s_add_u32 s101, s101, s99
    v_mov_b32 v2, 156648
    v_mov_b64 v[4:5], 0
    ds_write_b64 v2, v[4:5]
    ds_write_b64 v2, v[4:5] offset:8
    s_waitcnt lgkmcnt(0)
    s_barrier
    ds_read_b64_tr_b16 v[36:37], v10 offset:0
    ds_read_b64_tr_b16 v[38:39], v10 offset:512
    ds_read_b128 v[16:19], v8 offset:0
    ds_read_b64_tr_b16 v[40:41], v10 offset:1024
    ds_read_b64_tr_b16 v[42:43], v10 offset:1536
    ds_read_b128 v[20:23], v8 offset:2048
    ds_read_b64_tr_b16 v[44:45], v10 offset:2048
    ds_read_b64_tr_b16 v[46:47], v10 offset:2560
    ds_read_b128 v[24:27], v8 offset:4096
    ds_read_b128 v[28:31], v8 offset:6144
    ds_read_b128 v[32:35], v8 offset:8192
    s_waitcnt lgkmcnt(8)
    v_mfma_f32_16x16x32_bf16 v[80:83], v[36:39], v[16:19], 0
    ds_read_b64_tr_b16 v[68:69], v10 offset:12288
    s_waitcnt lgkmcnt(7)
    v_mfma_f32_16x16x32_bf16 v[100:103], v[40:43], v[16:19], 0
    ds_read_b64_tr_b16 v[70:71], v10 offset:12800
    s_waitcnt lgkmcnt(5)
    v_mfma_f32_16x16x32_bf16 v[120:123], v[16:19], v[44:47], 0
    ds_read_b128 v[48:51], v9 offset:0
    v_mfma_f32_16x16x32_bf16 v[84:87], v[36:39], v[20:23], 0
    ds_read_b64_tr_b16 v[72:73], v10 offset:13312
    v_mfma_f32_16x16x32_bf16 v[104:107], v[40:43], v[20:23], 0
    ds_read_b64_tr_b16 v[74:75], v10 offset:13824
    v_mfma_f32_16x16x32_bf16 v[124:127], v[20:23], v[44:47], 0
    ds_read_b128 v[52:55], v9 offset:2048
    s_waitcnt lgkmcnt(8)
    v_mfma_f32_16x16x32_bf16 v[88:91], v[36:39], v[24:27], 0
    ds_read_b64_tr_b16 v[76:77], v10 offset:14336
    v_mfma_f32_16x16x32_bf16 v[108:111], v[40:43], v[24:27], 0
    ds_read_b64_tr_b16 v[78:79], v10 offset:14848
    v_mfma_f32_16x16x32_bf16 v[128:131], v[24:27], v[44:47], 0
    ds_read_b128 v[56:59], v9 offset:4096
    s_waitcnt lgkmcnt(10)
    v_mfma_f32_16x16x32_bf16 v[92:95], v[36:39], v[28:31], 0
    ds_read_b128 v[60:63], v9 offset:6144
    v_mfma_f32_16x16x32_bf16 v[112:115], v[40:43], v[28:31], 0
    ds_read_b128 v[64:67], v9 offset:8192
    v_mfma_f32_16x16x32_bf16 v[132:135], v[28:31], v[44:47], 0
    v_add_u32 v10, 24576, v10
    s_waitcnt lgkmcnt(11)
    v_mfma_f32_16x16x32_bf16 v[96:99], v[36:39], v[32:35], 0
    v_add_u32 v8, 10240, v8
    v_mfma_f32_16x16x32_bf16 v[116:119], v[40:43], v[32:35], 0
    v_add_u32 v9, 10240, v9
    v_mfma_f32_16x16x32_bf16 v[136:139], v[32:35], v[44:47], 0
    v_mov_b64 v[224:225], 0
    v_mov_b64 v[226:227], 0
    v_mov_b64 v[228:229], 0
    s_waitcnt vmcnt(2)
    v_dot2c_f32_bf16 v224, s48, v208
    v_dot2c_f32_bf16 v225, v208, v208
    s_waitcnt vmcnt(1)
    v_dot2c_f32_bf16 v226, s48, v212
    v_dot2c_f32_bf16 v227, v212, v212
    s_waitcnt vmcnt(0)
    v_dot2c_f32_bf16 v228, s48, v216
    v_dot2c_f32_bf16 v229, v216, v216
    v_dot2c_f32_bf16 v224, s48, v209
    v_dot2c_f32_bf16 v225, v209, v209
    v_dot2c_f32_bf16 v226, s48, v213
    v_dot2c_f32_bf16 v227, v213, v213
    v_dot2c_f32_bf16 v228, s48, v217
    v_dot2c_f32_bf16 v229, v217, v217
    v_dot2c_f32_bf16 v224, s48, v210
    v_dot2c_f32_bf16 v225, v210, v210
    v_dot2c_f32_bf16 v226, s48, v214
    v_dot2c_f32_bf16 v227, v214, v214
    v_dot2c_f32_bf16 v228, s48, v218
    v_dot2c_f32_bf16 v229, v218, v218
    v_dot2c_f32_bf16 v224, s48, v211
    v_dot2c_f32_bf16 v225, v211, v211
    v_dot2c_f32_bf16 v226, s48, v215
    v_dot2c_f32_bf16 v227, v215, v215
    v_dot2c_f32_bf16 v228, s48, v219
    v_dot2c_f32_bf16 v229, v219, v219
    v_add_f32_dpp v224, v224, v224 quad_perm:[1,0,3,2] row_mask:0xf bank_mask:0xf
    v_add_f32_dpp v225, v225, v225 quad_perm:[1,0,3,2] row_mask:0xf bank_mask:0xf
    v_add_f32_dpp v226, v226, v226 quad_perm:[1,0,3,2] row_mask:0xf bank_mask:0xf
    v_add_f32_dpp v227, v227, v227 quad_perm:[1,0,3,2] row_mask:0xf bank_mask:0xf
    v_add_f32_dpp v228, v228, v228 quad_perm:[1,0,3,2] row_mask:0xf bank_mask:0xf
    v_add_f32_dpp v229, v229, v229 quad_perm:[1,0,3,2] row_mask:0xf bank_mask:0xf
    v_add_f32_dpp v224, v224, v224 quad_perm:[2,3,0,1] row_mask:0xf bank_mask:0xf
    v_add_f32_dpp v225, v225, v225 quad_perm:[2,3,0,1] row_mask:0xf bank_mask:0xf
    v_add_f32_dpp v226, v226, v226 quad_perm:[2,3,0,1] row_mask:0xf bank_mask:0xf
    v_add_f32_dpp v227, v227, v227 quad_perm:[2,3,0,1] row_mask:0xf bank_mask:0xf
    v_add_f32_dpp v228, v228, v228 quad_perm:[2,3,0,1] row_mask:0xf bank_mask:0xf
    s_waitcnt lgkmcnt(0)
    s_barrier
    v_mfma_f32_16x16x32_bf16 v[80:83], v[68:71], v[48:51], v[80:83]
    ds_read_b64_tr_b16 v[36:37], v10 offset:0
    v_mfma_f32_16x16x32_bf16 v[100:103], v[72:75], v[48:51], v[100:103]
    ds_read_b64_tr_b16 v[38:39], v10 offset:512
    v_mfma_f32_16x16x32_bf16 v[120:123], v[48:51], v[76:79], v[120:123]
    ds_read_b128 v[16:19], v8 offset:0
    v_mfma_f32_16x16x32_bf16 v[84:87], v[68:71], v[52:55], v[84:87]
    ds_read_b64_tr_b16 v[40:41], v10 offset:1024
    v_mfma_f32_16x16x32_bf16 v[104:107], v[72:75], v[52:55], v[104:107]
    ds_read_b64_tr_b16 v[42:43], v10 offset:1536
    v_mfma_f32_16x16x32_bf16 v[124:127], v[52:55], v[76:79], v[124:127]
    ds_read_b128 v[20:23], v8 offset:2048
    v_mfma_f32_16x16x32_bf16 v[88:91], v[68:71], v[56:59], v[88:91]
    ds_read_b64_tr_b16 v[44:45], v10 offset:2048
    v_mfma_f32_16x16x32_bf16 v[108:111], v[72:75], v[56:59], v[108:111]
    ds_read_b64_tr_b16 v[46:47], v10 offset:2560
    v_mfma_f32_16x16x32_bf16 v[128:131], v[56:59], v[76:79], v[128:131]
    ds_read_b128 v[24:27], v8 offset:4096
    v_mfma_f32_16x16x32_bf16 v[92:95], v[68:71], v[60:63], v[92:95]
    ds_read_b128 v[28:31], v8 offset:6144
    v_mfma_f32_16x16x32_bf16 v[112:115], v[72:75], v[60:63], v[112:115]
    ds_read_b128 v[32:35], v8 offset:8192
    v_mfma_f32_16x16x32_bf16 v[132:135], v[60:63], v[76:79], v[132:135]
    v_mfma_f32_16x16x32_bf16 v[96:99], v[68:71], v[64:67], v[96:99]
    v_mfma_f32_16x16x32_bf16 v[116:119], v[72:75], v[64:67], v[116:119]
    v_mfma_f32_16x16x32_bf16 v[136:139], v[64:67], v[76:79], v[136:139]
    s_waitcnt lgkmcnt(8)
    v_mfma_f32_16x16x32_bf16 v[80:83], v[36:39], v[16:19], v[80:83]
    ds_read_b64_tr_b16 v[68:69], v10 offset:12288
    s_waitcnt lgkmcnt(7)
    v_mfma_f32_16x16x32_bf16 v[100:103], v[40:43], v[16:19], v[100:103]
    ds_read_b64_tr_b16 v[70:71], v10 offset:12800
    s_waitcnt lgkmcnt(5)
    v_mfma_f32_16x16x32_bf16 v[120:123], v[16:19], v[44:47], v[120:123]
    ds_read_b128 v[48:51], v9 offset:0
    v_mfma_f32_16x16x32_bf16 v[84:87], v[36:39], v[20:23], v[84:87]
    ds_read_b64_tr_b16 v[72:73], v10 offset:13312
    v_mfma_f32_16x16x32_bf16 v[104:107], v[40:43], v[20:23], v[104:107]
    ds_read_b64_tr_b16 v[74:75], v10 offset:13824
    v_mfma_f32_16x16x32_bf16 v[124:127], v[20:23], v[44:47], v[124:127]
    ds_read_b128 v[52:55], v9 offset:2048
    s_waitcnt lgkmcnt(8)
    v_mfma_f32_16x16x32_bf16 v[88:91], v[36:39], v[24:27], v[88:91]
    ds_read_b64_tr_b16 v[76:77], v10 offset:14336
    v_mfma_f32_16x16x32_bf16 v[108:111], v[40:43], v[24:27], v[108:111]
    ds_read_b64_tr_b16 v[78:79], v10 offset:14848
    v_mfma_f32_16x16x32_bf16 v[128:131], v[24:27], v[44:47], v[128:131]
    ds_read_b128 v[56:59], v9 offset:4096
    s_waitcnt lgkmcnt(10)
    v_mfma_f32_16x16x32_bf16 v[92:95], v[36:39], v[28:31], v[92:95]
    ds_read_b128 v[60:63], v9 offset:6144
    v_mfma_f32_16x16x32_bf16 v[112:115], v[40:43], v[28:31], v[112:115]
    ds_read_b128 v[64:67], v9 offset:8192
    v_mfma_f32_16x16x32_bf16 v[132:135], v[28:31], v[44:47], v[132:135]
    v_add_u32 v10, 24576, v10
    s_waitcnt lgkmcnt(11)
    v_mfma_f32_16x16x32_bf16 v[96:99], v[36:39], v[32:35], v[96:99]
    v_add_u32 v8, 10240, v8
    v_mfma_f32_16x16x32_bf16 v[116:119], v[40:43], v[32:35], v[116:119]
    v_add_u32 v9, 10240, v9
    v_mfma_f32_16x16x32_bf16 v[136:139], v[32:35], v[44:47], v[136:139]
    v_add_f32_dpp v229, v229, v229 quad_perm:[2,3,0,1] row_mask:0xf bank_mask:0xf
    v_add_f32_dpp v224, v224, v224 row_half_mirror row_mask:0xf bank_mask:0xf
    v_add_f32_dpp v225, v225, v225 row_half_mirror row_mask:0xf bank_mask:0xf
    v_add_f32_dpp v226, v226, v226 row_half_mirror row_mask:0xf bank_mask:0xf
    v_add_f32_dpp v227, v227, v227 row_half_mirror row_mask:0xf bank_mask:0xf
    v_add_f32_dpp v228, v228, v228 row_half_mirror row_mask:0xf bank_mask:0xf
    v_add_f32_dpp v229, v229, v229 row_half_mirror row_mask:0xf bank_mask:0xf
    v_add_f32_dpp v224, v224, v224 row_mirror row_mask:0xf bank_mask:0xf
    v_add_f32_dpp v225, v225, v225 row_mirror row_mask:0xf bank_mask:0xf
    v_add_f32_dpp v226, v226, v226 row_mirror row_mask:0xf bank_mask:0xf
    v_add_f32_dpp v227, v227, v227 row_mirror row_mask:0xf bank_mask:0xf
    v_add_f32_dpp v228, v228, v228 row_mirror row_mask:0xf bank_mask:0xf
    v_add_f32_dpp v229, v229, v229 row_mirror row_mask:0xf bank_mask:0xf
    v_mov_b32 v232, v224
    v_mov_b32 v233, v225
    v_mov_b32 v234, v226
    v_mov_b32 v235, v227
    v_mov_b32 v236, v228
    v_mov_b32 v237, v229
    v_permlane16_swap_b32 v224, v232
    v_permlane16_swap_b32 v225, v233
    v_permlane16_swap_b32 v226, v234
    v_permlane16_swap_b32 v227, v235
    v_permlane16_swap_b32 v228, v236
    v_permlane16_swap_b32 v229, v237
    v_add_f32 v224, v224, v232
    v_add_f32 v225, v225, v233
    v_add_f32 v226, v226, v234
    v_add_f32 v227, v227, v235
    v_add_f32 v228, v228, v236
    v_add_f32 v229, v229, v237
    v_mov_b32 v232, v224
    v_mov_b32 v233, v225
    v_mov_b32 v234, v226
    v_mov_b32 v235, v227
    v_mov_b32 v236, v228
    v_mov_b32 v237, v229
    v_permlane32_swap_b32 v224, v232
    s_waitcnt lgkmcnt(0)
    s_barrier
    v_mfma_f32_16x16x32_bf16 v[80:83], v[68:71], v[48:51], v[80:83]
    ds_read_b64_tr_b16 v[36:37], v10 offset:0
    v_mfma_f32_16x16x32_bf16 v[100:103], v[72:75], v[48:51], v[100:103]
    ds_read_b64_tr_b16 v[38:39], v10 offset:512
    v_mfma_f32_16x16x32_bf16 v[120:123], v[48:51], v[76:79], v[120:123]
    ds_read_b128 v[16:19], v8 offset:0
    v_mfma_f32_16x16x32_bf16 v[84:87], v[68:71], v[52:55], v[84:87]
    ds_read_b64_tr_b16 v[40:41], v10 offset:1024
    v_mfma_f32_16x16x32_bf16 v[104:107], v[72:75], v[52:55], v[104:107]
    ds_read_b64_tr_b16 v[42:43], v10 offset:1536
    v_mfma_f32_16x16x32_bf16 v[124:127], v[52:55], v[76:79], v[124:127]
    ds_read_b128 v[20:23], v8 offset:2048
    v_mfma_f32_16x16x32_bf16 v[88:91], v[68:71], v[56:59], v[88:91]
    ds_read_b64_tr_b16 v[44:45], v10 offset:2048
    v_mfma_f32_16x16x32_bf16 v[108:111], v[72:75], v[56:59], v[108:111]
    ds_read_b64_tr_b16 v[46:47], v10 offset:2560
    v_mfma_f32_16x16x32_bf16 v[128:131], v[56:59], v[76:79], v[128:131]
    ds_read_b128 v[24:27], v8 offset:4096
    v_mfma_f32_16x16x32_bf16 v[92:95], v[68:71], v[60:63], v[92:95]
    ds_read_b128 v[28:31], v8 offset:6144
    v_mfma_f32_16x16x32_bf16 v[112:115], v[72:75], v[60:63], v[112:115]
    ds_read_b128 v[32:35], v8 offset:8192
    v_mfma_f32_16x16x32_bf16 v[132:135], v[60:63], v[76:79], v[132:135]
    v_mfma_f32_16x16x32_bf16 v[96:99], v[68:71], v[64:67], v[96:99]
    v_mfma_f32_16x16x32_bf16 v[116:119], v[72:75], v[64:67], v[116:119]
    v_mfma_f32_16x16x32_bf16 v[136:139], v[64:67], v[76:79], v[136:139]
    s_waitcnt lgkmcnt(8)
    v_mfma_f32_16x16x32_bf16 v[80:83], v[36:39], v[16:19], v[80:83]
    ds_read_b64_tr_b16 v[68:69], v10 offset:12288
    s_waitcnt lgkmcnt(7)
    v_mfma_f32_16x16x32_bf16 v[100:103], v[40:43], v[16:19], v[100:103]
    ds_read_b64_tr_b16 v[70:71], v10 offset:12800
    s_waitcnt lgkmcnt(5)
    v_mfma_f32_16x16x32_bf16 v[120:123], v[16:19], v[44:47], v[120:123]
    ds_read_b128 v[48:51], v9 offset:0
    v_mfma_f32_16x16x32_bf16 v[84:87], v[36:39], v[20:23], v[84:87]
    ds_read_b64_tr_b16 v[72:73], v10 offset:13312
    v_mfma_f32_16x16x32_bf16 v[104:107], v[40:43], v[20:23], v[104:107]
    ds_read_b64_tr_b16 v[74:75], v10 offset:13824
    v_mfma_f32_16x16x32_bf16 v[124:127], v[20:23], v[44:47], v[124:127]
    ds_read_b128 v[52:55], v9 offset:2048
    s_waitcnt lgkmcnt(8)
    v_mfma_f32_16x16x32_bf16 v[88:91], v[36:39], v[24:27], v[88:91]
    ds_read_b64_tr_b16 v[76:77], v10 offset:14336
    v_mfma_f32_16x16x32_bf16 v[108:111], v[40:43], v[24:27], v[108:111]
    ds_read_b64_tr_b16 v[78:79], v10 offset:14848
    v_mfma_f32_16x16x32_bf16 v[128:131], v[24:27], v[44:47], v[128:131]
    ds_read_b128 v[56:59], v9 offset:4096
    s_waitcnt lgkmcnt(10)
    v_mfma_f32_16x16x32_bf16 v[92:95], v[36:39], v[28:31], v[92:95]
    ds_read_b128 v[60:63], v9 offset:6144
    v_mfma_f32_16x16x32_bf16 v[112:115], v[40:43], v[28:31], v[112:115]
    ds_read_b128 v[64:67], v9 offset:8192
    v_mfma_f32_16x16x32_bf16 v[132:135], v[28:31], v[44:47], v[132:135]
    v_add_u32 v10, 4294918144, v10
    s_waitcnt lgkmcnt(11)
    v_mfma_f32_16x16x32_bf16 v[96:99], v[36:39], v[32:35], v[96:99]
    v_add_u32 v8, 10240, v8
    v_mfma_f32_16x16x32_bf16 v[116:119], v[40:43], v[32:35], v[116:119]
    v_add_u32 v9, 10240, v9
    v_mfma_f32_16x16x32_bf16 v[136:139], v[32:35], v[44:47], v[136:139]
    v_permlane32_swap_b32 v225, v233
    v_permlane32_swap_b32 v226, v234
    v_permlane32_swap_b32 v227, v235
    v_permlane32_swap_b32 v228, v236
    v_permlane32_swap_b32 v229, v237
    v_add_f32 v224, v224, v232
    v_add_f32 v225, v225, v233
    v_add_f32 v226, v226, v234
    v_add_f32 v227, v227, v235
    v_add_f32 v228, v228, v236
    v_add_f32 v229, v229, v237
    v_mul_f32 v224, 0x3b000000, v224
    v_mul_f32 v225, 0x3b000000, v225
    v_mul_f32 v226, 0x3b000000, v226
    v_mul_f32 v227, 0x3b000000, v227
    v_mul_f32 v228, 0x3b000000, v228
    v_mul_f32 v229, 0x3b000000, v229
    v_fma_f32 v225, -v224, v224, v225
    v_fma_f32 v227, -v226, v226, v227
    v_fma_f32 v229, -v228, v228, v229
    v_max_f32 v225, 0, v225
    v_max_f32 v227, 0, v227
    v_max_f32 v229, 0, v229
    v_add_f32 v225, 0x3727c5ac, v225
    v_add_f32 v227, 0x3727c5ac, v227
    v_add_f32 v229, 0x3727c5ac, v229
    v_rsq_f32 v225, v225
    v_rsq_f32 v227, v227
    v_rsq_f32 v229, v229
    s_mul_i32 s50, s44, 24
    s_add_u32 s50, s50, 156544
    v_mov_b32 v2, s50
    v_mul_f32 v224, -v224, v225
    v_mul_f32 v226, -v226, v227
    v_mul_f32 v228, -v228, v229
    ds_write_b64 v2, v[224:225] offset:0
    ds_write_b64 v2, v[226:227] offset:8
    ds_write_b64 v2, v[228:229] offset:16
    s_waitcnt lgkmcnt(0)
    s_barrier
    v_mfma_f32_16x16x32_bf16 v[80:83], v[68:71], v[48:51], v[80:83]
    ds_read_b64_tr_b16 v[36:37], v10 offset:0
    v_mfma_f32_16x16x32_bf16 v[100:103], v[72:75], v[48:51], v[100:103]
    ds_read_b64_tr_b16 v[38:39], v10 offset:512
    v_mfma_f32_16x16x32_bf16 v[120:123], v[48:51], v[76:79], v[120:123]
    ds_read_b128 v[16:19], v8 offset:0
    v_mfma_f32_16x16x32_bf16 v[84:87], v[68:71], v[52:55], v[84:87]
    ds_read_b64_tr_b16 v[40:41], v10 offset:1024
    v_mfma_f32_16x16x32_bf16 v[104:107], v[72:75], v[52:55], v[104:107]
    ds_read_b64_tr_b16 v[42:43], v10 offset:1536
    v_mfma_f32_16x16x32_bf16 v[124:127], v[52:55], v[76:79], v[124:127]
    ds_read_b128 v[20:23], v8 offset:2048
    v_mfma_f32_16x16x32_bf16 v[88:91], v[68:71], v[56:59], v[88:91]
    ds_read_b64_tr_b16 v[44:45], v10 offset:2048
    v_mfma_f32_16x16x32_bf16 v[108:111], v[72:75], v[56:59], v[108:111]
    ds_read_b64_tr_b16 v[46:47], v10 offset:2560
    v_mfma_f32_16x16x32_bf16 v[128:131], v[56:59], v[76:79], v[128:131]
    ds_read_b128 v[24:27], v8 offset:4096
    v_mfma_f32_16x16x32_bf16 v[92:95], v[68:71], v[60:63], v[92:95]
    ds_read_b128 v[28:31], v8 offset:6144
    v_mfma_f32_16x16x32_bf16 v[112:115], v[72:75], v[60:63], v[112:115]
    ds_read_b128 v[32:35], v8 offset:8192
    v_mfma_f32_16x16x32_bf16 v[132:135], v[60:63], v[76:79], v[132:135]
    v_mfma_f32_16x16x32_bf16 v[96:99], v[68:71], v[64:67], v[96:99]
    v_mfma_f32_16x16x32_bf16 v[116:119], v[72:75], v[64:67], v[116:119]
    v_mfma_f32_16x16x32_bf16 v[136:139], v[64:67], v[76:79], v[136:139]
    s_waitcnt lgkmcnt(8)
    v_mfma_f32_16x16x32_bf16 v[80:83], v[36:39], v[16:19], v[80:83]
    ds_read_b64_tr_b16 v[68:69], v10 offset:12288
    s_waitcnt lgkmcnt(7)
    v_mfma_f32_16x16x32_bf16 v[100:103], v[40:43], v[16:19], v[100:103]
    ds_read_b64_tr_b16 v[70:71], v10 offset:12800
    s_waitcnt lgkmcnt(5)
    v_mfma_f32_16x16x32_bf16 v[120:123], v[16:19], v[44:47], v[120:123]
    ds_read_b128 v[48:51], v9 offset:0
    v_mfma_f32_16x16x32_bf16 v[84:87], v[36:39], v[20:23], v[84:87]
    ds_read_b64_tr_b16 v[72:73], v10 offset:13312
    v_mfma_f32_16x16x32_bf16 v[104:107], v[40:43], v[20:23], v[104:107]
    ds_read_b64_tr_b16 v[74:75], v10 offset:13824
    v_mfma_f32_16x16x32_bf16 v[124:127], v[20:23], v[44:47], v[124:127]
    ds_read_b128 v[52:55], v9 offset:2048
    s_waitcnt lgkmcnt(8)
    v_mfma_f32_16x16x32_bf16 v[88:91], v[36:39], v[24:27], v[88:91]
    ds_read_b64_tr_b16 v[76:77], v10 offset:14336
    v_mfma_f32_16x16x32_bf16 v[108:111], v[40:43], v[24:27], v[108:111]
    ds_read_b64_tr_b16 v[78:79], v10 offset:14848
    v_mfma_f32_16x16x32_bf16 v[128:131], v[24:27], v[44:47], v[128:131]
    ds_read_b128 v[56:59], v9 offset:4096
    s_waitcnt lgkmcnt(10)
    v_mfma_f32_16x16x32_bf16 v[92:95], v[36:39], v[28:31], v[92:95]
    ds_read_b128 v[60:63], v9 offset:6144
    v_mfma_f32_16x16x32_bf16 v[112:115], v[40:43], v[28:31], v[112:115]
    ds_read_b128 v[64:67], v9 offset:8192
    v_mfma_f32_16x16x32_bf16 v[132:135], v[28:31], v[44:47], v[132:135]
    v_add_u32 v10, 24576, v10
    s_waitcnt lgkmcnt(11)
    v_mfma_f32_16x16x32_bf16 v[96:99], v[36:39], v[32:35], v[96:99]
    v_add_u32 v8, 10240, v8
    v_mfma_f32_16x16x32_bf16 v[116:119], v[40:43], v[32:35], v[116:119]
    v_add_u32 v9, 10240, v9
    v_mfma_f32_16x16x32_bf16 v[136:139], v[32:35], v[44:47], v[136:139]
    s_mul_i32 s50, s47, 192
    s_mov_b32 s51, 0x15555556
    s_and_b32 s52, s44, 1
    s_lshr_b32 s54, s44, 1
    s_mul_i32 s89, s52, 12288
    s_mul_i32 s55, s54, 6144
    s_add_u32 s89, s89, s55
    s_mul_i32 s90, s54, 88064
    s_and_b32 s88, s45, 1
    s_lshl_b32 s88, s88, 2
    s_lshl_b32 s52, s52, 1
    v_add_u32 v1, 0, v0
    v_mul_hi_u32 v2, v1, s51
    v_mul_u32_u24 v3, 12, v2
    v_sub_u32 v3, v1, v3
    v_mul_u32_u24 v2, 2752, v2
    v_add_u32 v2, s50, v2
    v_subrev_u32 v2, 0, v2
    v_subrev_u32 v3, s52, v3
    v_add_u32 v1, 12, v3
    v_cmp_gt_i32 vcc, 0, v3
    s_nop 1
    v_cndmask_b32 v3, v3, v1, vcc
    v_lshl_add_u32 v155, v3, 4, v2
    v_add_u32 v1, 64, v0
    s_waitcnt lgkmcnt(0)
    s_barrier
    v_mfma_f32_16x16x32_bf16 v[80:83], v[68:71], v[48:51], v[80:83]
    ds_read_b64_tr_b16 v[36:37], v10 offset:0
    v_mfma_f32_16x16x32_bf16 v[100:103], v[72:75], v[48:51], v[100:103]
    ds_read_b64_tr_b16 v[38:39], v10 offset:512
    v_mfma_f32_16x16x32_bf16 v[120:123], v[48:51], v[76:79], v[120:123]
    ds_read_b128 v[16:19], v8 offset:0
    v_mfma_f32_16x16x32_bf16 v[84:87], v[68:71], v[52:55], v[84:87]
    ds_read_b64_tr_b16 v[40:41], v10 offset:1024
    v_mfma_f32_16x16x32_bf16 v[104:107], v[72:75], v[52:55], v[104:107]
    ds_read_b64_tr_b16 v[42:43], v10 offset:1536
    v_mfma_f32_16x16x32_bf16 v[124:127], v[52:55], v[76:79], v[124:127]
    ds_read_b128 v[20:23], v8 offset:2048
    v_mfma_f32_16x16x32_bf16 v[88:91], v[68:71], v[56:59], v[88:91]
    ds_read_b64_tr_b16 v[44:45], v10 offset:2048
    v_mfma_f32_16x16x32_bf16 v[108:111], v[72:75], v[56:59], v[108:111]
    ds_read_b64_tr_b16 v[46:47], v10 offset:2560
    v_mfma_f32_16x16x32_bf16 v[128:131], v[56:59], v[76:79], v[128:131]
    ds_read_b128 v[24:27], v8 offset:4096
    v_mfma_f32_16x16x32_bf16 v[92:95], v[68:71], v[60:63], v[92:95]
    ds_read_b128 v[28:31], v8 offset:6144
    v_mfma_f32_16x16x32_bf16 v[112:115], v[72:75], v[60:63], v[112:115]
    ds_read_b128 v[32:35], v8 offset:8192
    v_mfma_f32_16x16x32_bf16 v[132:135], v[60:63], v[76:79], v[132:135]
    v_mfma_f32_16x16x32_bf16 v[96:99], v[68:71], v[64:67], v[96:99]
    v_mfma_f32_16x16x32_bf16 v[116:119], v[72:75], v[64:67], v[116:119]
    v_mfma_f32_16x16x32_bf16 v[136:139], v[64:67], v[76:79], v[136:139]
    s_waitcnt lgkmcnt(8)
    v_mfma_f32_16x16x32_bf16 v[80:83], v[36:39], v[16:19], v[80:83]
    ds_read_b64_tr_b16 v[68:69], v10 offset:12288
    s_waitcnt lgkmcnt(7)
    v_mfma_f32_16x16x32_bf16 v[100:103], v[40:43], v[16:19], v[100:103]
    ds_read_b64_tr_b16 v[70:71], v10 offset:12800
    s_waitcnt lgkmcnt(5)
    v_mfma_f32_16x16x32_bf16 v[120:123], v[16:19], v[44:47], v[120:123]
    ds_read_b128 v[48:51], v9 offset:0
    v_mfma_f32_16x16x32_bf16 v[84:87], v[36:39], v[20:23], v[84:87]
    ds_read_b64_tr_b16 v[72:73], v10 offset:13312
    v_mfma_f32_16x16x32_bf16 v[104:107], v[40:43], v[20:23], v[104:107]
    ds_read_b64_tr_b16 v[74:75], v10 offset:13824
    v_mfma_f32_16x16x32_bf16 v[124:127], v[20:23], v[44:47], v[124:127]
    ds_read_b128 v[52:55], v9 offset:2048
    s_waitcnt lgkmcnt(8)
    v_mfma_f32_16x16x32_bf16 v[88:91], v[36:39], v[24:27], v[88:91]
    ds_read_b64_tr_b16 v[76:77], v10 offset:14336
    v_mfma_f32_16x16x32_bf16 v[108:111], v[40:43], v[24:27], v[108:111]
    ds_read_b64_tr_b16 v[78:79], v10 offset:14848
    v_mfma_f32_16x16x32_bf16 v[128:131], v[24:27], v[44:47], v[128:131]
    ds_read_b128 v[56:59], v9 offset:4096
    s_waitcnt lgkmcnt(10)
    v_mfma_f32_16x16x32_bf16 v[92:95], v[36:39], v[28:31], v[92:95]
    ds_read_b128 v[60:63], v9 offset:6144
    v_mfma_f32_16x16x32_bf16 v[112:115], v[40:43], v[28:31], v[112:115]
    ds_read_b128 v[64:67], v9 offset:8192
    v_mfma_f32_16x16x32_bf16 v[132:135], v[28:31], v[44:47], v[132:135]
    v_add_u32 v10, 24576, v10
    s_waitcnt lgkmcnt(11)
    v_mfma_f32_16x16x32_bf16 v[96:99], v[36:39], v[32:35], v[96:99]
    v_add_u32 v8, 10240, v8
    v_mfma_f32_16x16x32_bf16 v[116:119], v[40:43], v[32:35], v[116:119]
    v_add_u32 v9, 10240, v9
    v_mfma_f32_16x16x32_bf16 v[136:139], v[32:35], v[44:47], v[136:139]
    v_mul_hi_u32 v2, v1, s51
    v_mul_u32_u24 v3, 12, v2
    v_sub_u32 v3, v1, v3
    v_mul_u32_u24 v2, 2752, v2
    v_add_u32 v2, s50, v2
    v_subrev_u32 v2, 1024, v2
    v_subrev_u32 v3, s52, v3
    v_add_u32 v1, 12, v3
    v_cmp_gt_i32 vcc, 0, v3
    s_nop 1
    v_cndmask_b32 v3, v3, v1, vcc
    v_lshl_add_u32 v156, v3, 4, v2
    v_add_u32 v1, 128, v0
    v_mul_hi_u32 v2, v1, s51
    v_mul_u32_u24 v3, 12, v2
    v_sub_u32 v3, v1, v3
    v_mul_u32_u24 v2, 2752, v2
    v_add_u32 v2, s50, v2
    v_subrev_u32 v2, 2048, v2
    v_subrev_u32 v3, s52, v3
    v_add_u32 v1, 12, v3
    v_cmp_gt_i32 vcc, 0, v3
    s_nop 1
    v_cndmask_b32 v3, v3, v1, vcc
    v_lshl_add_u32 v157, v3, 4, v2
    s_mov_b32 s54, 81920
    s_waitcnt lgkmcnt(0)
    s_barrier
    v_mfma_f32_16x16x32_bf16 v[80:83], v[68:71], v[48:51], v[80:83]
    ds_read_b64_tr_b16 v[36:37], v10 offset:0
    v_mfma_f32_16x16x32_bf16 v[100:103], v[72:75], v[48:51], v[100:103]
    ds_read_b64_tr_b16 v[38:39], v10 offset:512
    v_mfma_f32_16x16x32_bf16 v[120:123], v[48:51], v[76:79], v[120:123]
    ds_read_b128 v[16:19], v8 offset:0
    v_mfma_f32_16x16x32_bf16 v[84:87], v[68:71], v[52:55], v[84:87]
    ds_read_b64_tr_b16 v[40:41], v10 offset:1024
    v_mfma_f32_16x16x32_bf16 v[104:107], v[72:75], v[52:55], v[104:107]
    ds_read_b64_tr_b16 v[42:43], v10 offset:1536
    v_mfma_f32_16x16x32_bf16 v[124:127], v[52:55], v[76:79], v[124:127]
    ds_read_b128 v[20:23], v8 offset:2048
    v_mfma_f32_16x16x32_bf16 v[88:91], v[68:71], v[56:59], v[88:91]
    ds_read_b64_tr_b16 v[44:45], v10 offset:2048
    v_mfma_f32_16x16x32_bf16 v[108:111], v[72:75], v[56:59], v[108:111]
    ds_read_b64_tr_b16 v[46:47], v10 offset:2560
    v_mfma_f32_16x16x32_bf16 v[128:131], v[56:59], v[76:79], v[128:131]
    ds_read_b128 v[24:27], v8 offset:4096
    v_mfma_f32_16x16x32_bf16 v[92:95], v[68:71], v[60:63], v[92:95]
    ds_read_b128 v[28:31], v8 offset:6144
    v_mfma_f32_16x16x32_bf16 v[112:115], v[72:75], v[60:63], v[112:115]
    ds_read_b128 v[32:35], v8 offset:8192
    v_mfma_f32_16x16x32_bf16 v[132:135], v[60:63], v[76:79], v[132:135]
    v_mfma_f32_16x16x32_bf16 v[96:99], v[68:71], v[64:67], v[96:99]
    v_mfma_f32_16x16x32_bf16 v[116:119], v[72:75], v[64:67], v[116:119]
    v_mfma_f32_16x16x32_bf16 v[136:139], v[64:67], v[76:79], v[136:139]
    s_waitcnt lgkmcnt(8)
    v_mfma_f32_16x16x32_bf16 v[80:83], v[36:39], v[16:19], v[80:83]
    ds_read_b64_tr_b16 v[68:69], v10 offset:12288
    s_waitcnt lgkmcnt(7)
    v_mfma_f32_16x16x32_bf16 v[100:103], v[40:43], v[16:19], v[100:103]
    ds_read_b64_tr_b16 v[70:71], v10 offset:12800
    s_waitcnt lgkmcnt(5)
    v_mfma_f32_16x16x32_bf16 v[120:123], v[16:19], v[44:47], v[120:123]
    ds_read_b128 v[48:51], v9 offset:0
    v_mfma_f32_16x16x32_bf16 v[84:87], v[36:39], v[20:23], v[84:87]
    ds_read_b64_tr_b16 v[72:73], v10 offset:13312
    v_mfma_f32_16x16x32_bf16 v[104:107], v[40:43], v[20:23], v[104:107]
    ds_read_b64_tr_b16 v[74:75], v10 offset:13824
    v_mfma_f32_16x16x32_bf16 v[124:127], v[20:23], v[44:47], v[124:127]
    ds_read_b128 v[52:55], v9 offset:2048
    s_waitcnt lgkmcnt(8)
    v_mfma_f32_16x16x32_bf16 v[88:91], v[36:39], v[24:27], v[88:91]
    ds_read_b64_tr_b16 v[76:77], v10 offset:14336
    v_mfma_f32_16x16x32_bf16 v[108:111], v[40:43], v[24:27], v[108:111]
    ds_read_b64_tr_b16 v[78:79], v10 offset:14848
    v_mfma_f32_16x16x32_bf16 v[128:131], v[24:27], v[44:47], v[128:131]
    ds_read_b128 v[56:59], v9 offset:4096
    s_waitcnt lgkmcnt(10)
    v_mfma_f32_16x16x32_bf16 v[92:95], v[36:39], v[28:31], v[92:95]
    ds_read_b128 v[60:63], v9 offset:6144
    v_mfma_f32_16x16x32_bf16 v[112:115], v[40:43], v[28:31], v[112:115]
    ds_read_b128 v[64:67], v9 offset:8192
    v_mfma_f32_16x16x32_bf16 v[132:135], v[28:31], v[44:47], v[132:135]
    v_add_u32 v10, 4294918144, v10
    s_waitcnt lgkmcnt(11)
    v_mfma_f32_16x16x32_bf16 v[96:99], v[36:39], v[32:35], v[96:99]
    v_add_u32 v8, 10240, v8
    v_mfma_f32_16x16x32_bf16 v[116:119], v[40:43], v[32:35], v[116:119]
    v_add_u32 v9, 10240, v9
    v_mfma_f32_16x16x32_bf16 v[136:139], v[32:35], v[44:47], v[136:139]
    s_lshl_b32 s50, s44, 5
    s_lshr_b32 s51, s44, 1
    s_lshl_b32 s51, s51, 5
    s_add_u32 s51, s51, 128
    v_lshrrev_b32 v1, 5, v0
    v_bfe_u32 v2, v0, 2, 2
    v_lshl_add_u32 v1, v1, 4, v2
    v_mul_u32_u24 v1, 192, v1
    v_bfe_u32 v2, v0, 4, 1
    v_mul_u32_u24 v3, 12288, v2
    v_add3_u32 v1, v1, v3, s54
    v_and_b32 v3, 3, v0
    v_lshlrev_b32 v3, 3, v3
    v_lshl_add_u32 v3, v2, 5, v3
    v_add3_u32 v149, v1, v3, s50
    v_add_u32 v3, s51, v3
    v_subrev_u32 v4, 192, v3
    v_cmp_le_u32 vcc, 192, v3
    s_nop 1
    v_cndmask_b32 v3, v3, v4, vcc
    v_add_u32 v152, v1, v3
    s_and_b32 s50, s44, 1
    s_lshl_b32 s50, s50, 13
    v_add_u32 v153, s50, v148
    v_xor_b32 v154, 0x2000, v153
    s_waitcnt lgkmcnt(0)
    s_barrier
    v_mfma_f32_16x16x32_bf16 v[80:83], v[68:71], v[48:51], v[80:83]
    ds_read_b64_tr_b16 v[36:37], v10 offset:0
    v_mfma_f32_16x16x32_bf16 v[100:103], v[72:75], v[48:51], v[100:103]
    ds_read_b64_tr_b16 v[38:39], v10 offset:512
    v_mfma_f32_16x16x32_bf16 v[120:123], v[48:51], v[76:79], v[120:123]
    ds_read_b128 v[16:19], v8 offset:0
    v_mfma_f32_16x16x32_bf16 v[84:87], v[68:71], v[52:55], v[84:87]
    ds_read_b64_tr_b16 v[40:41], v10 offset:1024
    v_mfma_f32_16x16x32_bf16 v[104:107], v[72:75], v[52:55], v[104:107]
    ds_read_b64_tr_b16 v[42:43], v10 offset:1536
    v_mfma_f32_16x16x32_bf16 v[124:127], v[52:55], v[76:79], v[124:127]
    ds_read_b128 v[20:23], v8 offset:2048
    v_mfma_f32_16x16x32_bf16 v[88:91], v[68:71], v[56:59], v[88:91]
    ds_read_b64_tr_b16 v[44:45], v10 offset:2048
    v_mfma_f32_16x16x32_bf16 v[108:111], v[72:75], v[56:59], v[108:111]
    ds_read_b64_tr_b16 v[46:47], v10 offset:2560
    v_mfma_f32_16x16x32_bf16 v[128:131], v[56:59], v[76:79], v[128:131]
    ds_read_b128 v[24:27], v8 offset:4096
    v_mfma_f32_16x16x32_bf16 v[92:95], v[68:71], v[60:63], v[92:95]
    ds_read_b128 v[28:31], v8 offset:6144
    v_mfma_f32_16x16x32_bf16 v[112:115], v[72:75], v[60:63], v[112:115]
    ds_read_b128 v[32:35], v8 offset:8192
    v_mfma_f32_16x16x32_bf16 v[132:135], v[60:63], v[76:79], v[132:135]
    v_mfma_f32_16x16x32_bf16 v[96:99], v[68:71], v[64:67], v[96:99]
    v_mfma_f32_16x16x32_bf16 v[116:119], v[72:75], v[64:67], v[116:119]
    v_mfma_f32_16x16x32_bf16 v[136:139], v[64:67], v[76:79], v[136:139]
    s_waitcnt lgkmcnt(8)
    v_mfma_f32_16x16x32_bf16 v[80:83], v[36:39], v[16:19], v[80:83]
    ds_read_b64_tr_b16 v[68:69], v10 offset:12288
    s_waitcnt lgkmcnt(7)
    v_mfma_f32_16x16x32_bf16 v[100:103], v[40:43], v[16:19], v[100:103]
    ds_read_b64_tr_b16 v[70:71], v10 offset:12800
    s_waitcnt lgkmcnt(5)
    v_mfma_f32_16x16x32_bf16 v[120:123], v[16:19], v[44:47], v[120:123]
    ds_read_b128 v[48:51], v9 offset:0
    v_mfma_f32_16x16x32_bf16 v[84:87], v[36:39], v[20:23], v[84:87]
    ds_read_b64_tr_b16 v[72:73], v10 offset:13312
    v_mfma_f32_16x16x32_bf16 v[104:107], v[40:43], v[20:23], v[104:107]
    ds_read_b64_tr_b16 v[74:75], v10 offset:13824
    v_mfma_f32_16x16x32_bf16 v[124:127], v[20:23], v[44:47], v[124:127]
    ds_read_b128 v[52:55], v9 offset:2048
    s_waitcnt lgkmcnt(8)
    v_mfma_f32_16x16x32_bf16 v[88:91], v[36:39], v[24:27], v[88:91]
    ds_read_b64_tr_b16 v[76:77], v10 offset:14336
    v_mfma_f32_16x16x32_bf16 v[108:111], v[40:43], v[24:27], v[108:111]
    ds_read_b64_tr_b16 v[78:79], v10 offset:14848
    v_mfma_f32_16x16x32_bf16 v[128:131], v[24:27], v[44:47], v[128:131]
    ds_read_b128 v[56:59], v9 offset:4096
    s_waitcnt lgkmcnt(10)
    v_mfma_f32_16x16x32_bf16 v[92:95], v[36:39], v[28:31], v[92:95]
    ds_read_b128 v[60:63], v9 offset:6144
    v_mfma_f32_16x16x32_bf16 v[112:115], v[40:43], v[28:31], v[112:115]
    ds_read_b128 v[64:67], v9 offset:8192
    v_mfma_f32_16x16x32_bf16 v[132:135], v[28:31], v[44:47], v[132:135]
    v_add_u32 v10, 24576, v10
    s_waitcnt lgkmcnt(11)
    v_mfma_f32_16x16x32_bf16 v[96:99], v[36:39], v[32:35], v[96:99]
    v_add_u32 v8, 10240, v8
    v_mfma_f32_16x16x32_bf16 v[116:119], v[40:43], v[32:35], v[116:119]
    v_add_u32 v9, 10240, v9
    v_mfma_f32_16x16x32_bf16 v[136:139], v[32:35], v[44:47], v[136:139]
    buffer_load_dwordx2 v[150:151], v14, s[28:31], 0 offen offset:128 sc1
    s_mul_i32 s50, s42, 11
    s_lshr_b32 s50, s50, 1
    s_lshl_b32 s50, s50, 12
    s_lshl_b32 s51, s44, 10
    s_add_u32 s64, s50, s51
    s_add_u32 s50, s50, 4096
    s_cmp_eq_u32 s50, 90112
    s_cselect_b32 s50, 0, s50
    s_add_u32 s65, s50, s51
    s_add_u32 s50, s50, 4096
    s_cmp_eq_u32 s50, 90112
    s_cselect_b32 s50, 0, s50
    s_add_u32 s66, s50, s51
    s_add_u32 s50, s50, 4096
    s_cmp_eq_u32 s50, 90112
    s_cselect_b32 s50, 0, s50
    s_add_u32 s67, s50, s51
    s_add_u32 s50, s50, 4096
    s_cmp_eq_u32 s50, 90112
    s_cselect_b32 s50, 0, s50
    s_add_u32 s68, s50, s51
    s_add_u32 s50, s50, 4096
    s_cmp_eq_u32 s50, 90112
    s_cselect_b32 s50, 0, s50
    s_add_u32 s69, s50, s51
    s_add_u32 s50, s50, 4096
    s_cmp_eq_u32 s50, 90112
    s_cselect_b32 s50, 0, s50
    s_add_u32 s70, s50, s51
    s_add_u32 s50, s50, 4096
    s_cmp_eq_u32 s50, 90112
    s_cselect_b32 s50, 0, s50
    s_add_u32 s71, s50, s51
    s_add_u32 s50, s50, 4096
    s_cmp_eq_u32 s50, 90112
    s_cselect_b32 s50, 0, s50
    s_add_u32 s72, s50, s51
    s_add_u32 s50, s50, 4096
    s_cmp_eq_u32 s50, 90112
    s_cselect_b32 s50, 0, s50
    s_add_u32 s73, s50, s51
    s_add_u32 s50, s50, 4096
    s_cmp_eq_u32 s50, 90112
    s_cselect_b32 s50, 0, s50
    s_add_u32 s74, s50, s51
    s_add_u32 s50, s50, 4096
    s_cmp_eq_u32 s50, 90112
    s_cselect_b32 s50, 0, s50
    s_add_u32 s75, s50, s51
    s_add_u32 s50, s50, 4096
    s_cmp_eq_u32 s50, 90112
    s_cselect_b32 s50, 0, s50
    s_add_u32 s76, s50, s51
    s_add_u32 s50, s50, 4096
    s_cmp_eq_u32 s50, 90112
    s_cselect_b32 s50, 0, s50
    s_add_u32 s77, s50, s51
    s_add_u32 s50, s50, 4096
    s_cmp_eq_u32 s50, 90112
    s_cselect_b32 s50, 0, s50
    s_add_u32 s78, s50, s51
    s_add_u32 s50, s50, 4096
    s_cmp_eq_u32 s50, 90112
    s_cselect_b32 s50, 0, s50
    s_add_u32 s79, s50, s51
    s_add_u32 s50, s50, 4096
    s_cmp_eq_u32 s50, 90112
    s_cselect_b32 s50, 0, s50
    s_add_u32 s80, s50, s51
    s_add_u32 s50, s50, 4096
    s_cmp_eq_u32 s50, 90112
    s_cselect_b32 s50, 0, s50
    s_add_u32 s81, s50, s51
    s_add_u32 s50, s50, 4096
    s_cmp_eq_u32 s50, 90112
    s_cselect_b32 s50, 0, s50
    s_add_u32 s82, s50, s51
    s_add_u32 s50, s50, 4096
    s_cmp_eq_u32 s50, 90112
    s_cselect_b32 s50, 0, s50
    s_add_u32 s83, s50, s51
    s_add_u32 s50, s50, 4096
    s_cmp_eq_u32 s50, 90112
    s_cselect_b32 s50, 0, s50
    s_add_u32 s84, s50, s51
    s_add_u32 s50, s50, 4096
    s_cmp_eq_u32 s50, 90112
    s_cselect_b32 s50, 0, s50
    s_add_u32 s85, s50, s51
    s_add_u32 s50, s50, 4096
    s_cmp_eq_u32 s50, 90112
    s_cselect_b32 s50, 0, s50
    s_waitcnt lgkmcnt(0)
    s_barrier
    v_mfma_f32_16x16x32_bf16 v[80:83], v[68:71], v[48:51], v[80:83]
    ds_read_b64_tr_b16 v[36:37], v10 offset:0
    v_mfma_f32_16x16x32_bf16 v[100:103], v[72:75], v[48:51], v[100:103]
    ds_read_b64_tr_b16 v[38:39], v10 offset:512
    v_mfma_f32_16x16x32_bf16 v[120:123], v[48:51], v[76:79], v[120:123]
    ds_read_b128 v[16:19], v8 offset:0
    v_mfma_f32_16x16x32_bf16 v[84:87], v[68:71], v[52:55], v[84:87]
    ds_read_b64_tr_b16 v[40:41], v10 offset:1024
    v_mfma_f32_16x16x32_bf16 v[104:107], v[72:75], v[52:55], v[104:107]
    ds_read_b64_tr_b16 v[42:43], v10 offset:1536
    v_mfma_f32_16x16x32_bf16 v[124:127], v[52:55], v[76:79], v[124:127]
    ds_read_b128 v[20:23], v8 offset:2048
    v_mfma_f32_16x16x32_bf16 v[88:91], v[68:71], v[56:59], v[88:91]
    ds_read_b64_tr_b16 v[44:45], v10 offset:2048
    v_mfma_f32_16x16x32_bf16 v[108:111], v[72:75], v[56:59], v[108:111]
    ds_read_b64_tr_b16 v[46:47], v10 offset:2560
    v_mfma_f32_16x16x32_bf16 v[128:131], v[56:59], v[76:79], v[128:131]
    ds_read_b128 v[24:27], v8 offset:4096
    v_mfma_f32_16x16x32_bf16 v[92:95], v[68:71], v[60:63], v[92:95]
    ds_read_b128 v[28:31], v8 offset:6144
    v_mfma_f32_16x16x32_bf16 v[112:115], v[72:75], v[60:63], v[112:115]
    ds_read_b128 v[32:35], v8 offset:8192
    v_mfma_f32_16x16x32_bf16 v[132:135], v[60:63], v[76:79], v[132:135]
    v_mfma_f32_16x16x32_bf16 v[96:99], v[68:71], v[64:67], v[96:99]
    v_mfma_f32_16x16x32_bf16 v[116:119], v[72:75], v[64:67], v[116:119]
    v_mfma_f32_16x16x32_bf16 v[136:139], v[64:67], v[76:79], v[136:139]
    s_waitcnt lgkmcnt(8)
    v_mfma_f32_16x16x32_bf16 v[80:83], v[36:39], v[16:19], v[80:83]
    ds_read_b64_tr_b16 v[68:69], v10 offset:12288
    s_waitcnt lgkmcnt(7)
    v_mfma_f32_16x16x32_bf16 v[100:103], v[40:43], v[16:19], v[100:103]
    ds_read_b64_tr_b16 v[70:71], v10 offset:12800
    s_waitcnt lgkmcnt(5)
    v_mfma_f32_16x16x32_bf16 v[120:123], v[16:19], v[44:47], v[120:123]
    ds_read_b128 v[48:51], v9 offset:0
    v_mfma_f32_16x16x32_bf16 v[84:87], v[36:39], v[20:23], v[84:87]
    ds_read_b64_tr_b16 v[72:73], v10 offset:13312
    v_mfma_f32_16x16x32_bf16 v[104:107], v[40:43], v[20:23], v[104:107]
    ds_read_b64_tr_b16 v[74:75], v10 offset:13824
    v_mfma_f32_16x16x32_bf16 v[124:127], v[20:23], v[44:47], v[124:127]
    ds_read_b128 v[52:55], v9 offset:2048
    s_waitcnt lgkmcnt(8)
    v_mfma_f32_16x16x32_bf16 v[88:91], v[36:39], v[24:27], v[88:91]
    ds_read_b64_tr_b16 v[76:77], v10 offset:14336
    v_mfma_f32_16x16x32_bf16 v[108:111], v[40:43], v[24:27], v[108:111]
    ds_read_b64_tr_b16 v[78:79], v10 offset:14848
    v_mfma_f32_16x16x32_bf16 v[128:131], v[24:27], v[44:47], v[128:131]
    ds_read_b128 v[56:59], v9 offset:4096
    s_waitcnt lgkmcnt(10)
    v_mfma_f32_16x16x32_bf16 v[92:95], v[36:39], v[28:31], v[92:95]
    ds_read_b128 v[60:63], v9 offset:6144
    v_mfma_f32_16x16x32_bf16 v[112:115], v[40:43], v[28:31], v[112:115]
    ds_read_b128 v[64:67], v9 offset:8192
    v_mfma_f32_16x16x32_bf16 v[132:135], v[28:31], v[44:47], v[132:135]
    s_waitcnt lgkmcnt(11)
    v_mfma_f32_16x16x32_bf16 v[96:99], v[36:39], v[32:35], v[96:99]
    v_mfma_f32_16x16x32_bf16 v[116:119], v[40:43], v[32:35], v[116:119]
    v_mfma_f32_16x16x32_bf16 v[136:139], v[32:35], v[44:47], v[136:139]
    s_waitcnt lgkmcnt(0)
    s_barrier
    v_mfma_f32_16x16x32_bf16 v[96:99], v[68:71], v[64:67], v[96:99]
    ds_read2_b32 v[16:17], v11 offset0:0 offset1:128
    v_mfma_f32_16x16x32_bf16 v[116:119], v[72:75], v[64:67], v[116:119]
    ds_read2_b32 v[18:19], v11 offset0:16 offset1:144
    v_mfma_f32_16x16x32_bf16 v[136:139], v[64:67], v[76:79], v[136:139]
    ds_read2_b32 v[20:21], v11 offset0:32 offset1:160
    v_mfma_f32_16x16x32_bf16 v[80:83], v[68:71], v[48:51], v[80:83]
    ds_read2_b32 v[22:23], v11 offset0:48 offset1:176
    v_mfma_f32_16x16x32_bf16 v[100:103], v[72:75], v[48:51], v[100:103]
    ds_read2_b32 v[24:25], v11 offset0:64 offset1:192
    v_mfma_f32_16x16x32_bf16 v[120:123], v[48:51], v[76:79], v[120:123]
    ds_read_b128 v[28:31], v12 offset:0
    v_mfma_f32_16x16x32_bf16 v[84:87], v[68:71], v[52:55], v[84:87]
    ds_read_b128 v[208:211], v12 offset:512
    v_mfma_f32_16x16x32_bf16 v[104:107], v[72:75], v[52:55], v[104:107]
    ds_read_b128 v[32:35], v12 offset:64
    v_mfma_f32_16x16x32_bf16 v[124:127], v[52:55], v[76:79], v[124:127]
    ds_read_b128 v[212:215], v12 offset:576
    v_mfma_f32_16x16x32_bf16 v[88:91], v[68:71], v[56:59], v[88:91]
    ds_read_b128 v[36:39], v12 offset:128
    v_mfma_f32_16x16x32_bf16 v[108:111], v[72:75], v[56:59], v[108:111]
    ds_read_b128 v[216:219], v12 offset:640
    v_mfma_f32_16x16x32_bf16 v[128:131], v[56:59], v[76:79], v[128:131]
    ds_read_b128 v[40:43], v12 offset:192
    v_mfma_f32_16x16x32_bf16 v[92:95], v[68:71], v[60:63], v[92:95]
    ds_read_b128 v[220:223], v12 offset:704
    v_mfma_f32_16x16x32_bf16 v[112:115], v[72:75], v[60:63], v[112:115]
    ds_read_b128 v[44:47], v12 offset:256
    v_mfma_f32_16x16x32_bf16 v[132:135], v[60:63], v[76:79], v[132:135]
    ds_read_b128 v[224:227], v12 offset:768
    v_add_u32 v8, s91, v148
    v_add_u32 v9, 0x8000, v8
    s_waitcnt vmcnt(0)
    s_mov_b32 s57, 0
A_REGPOLL:
    v_readfirstlane_b32 s50, v150
    v_readfirstlane_b32 s51, v151
    s_and_b32 s52, s50, 31
    s_cmp_eq_u32 s52, 16
    s_cbranch_scc1 A_REGOK
    s_add_u32 s57, s57, 1
    s_cmp_ge_u32 s57, 20000
    s_cbranch_scc1 A_REGOK
    buffer_load_dwordx2 v[150:151], v14, s[28:31], 0 offen offset:128 sc1
    s_waitcnt vmcnt(0)
    s_branch A_REGPOLL
A_REGOK:
    s_bfe_u32 s52, s50, 458757
    s_bfe_u32 s53, s50, 655372
    s_mul_i32 s52, s52, s52
    s_lshl_b32 s53, s53, 4
    s_cmp_lg_u32 s52, s53
    s_cselect_b32 s49, 1, 0
    s_and_b32 s50, s50, 0xffc00000
    s_or_b32 s50, s50, 0x5a5a0
    v_mov_b32 v150, s50
    v_mov_b32 v151, s51
    v_mov_b32_dpp v228, v96 row_newbcast:0 row_mask:0xf bank_mask:0xf
    v_mov_b32_dpp v232, v116 row_newbcast:0 row_mask:0xf bank_mask:0xf
    v_mov_b32_dpp v229, v97 row_newbcast:0 row_mask:0xf bank_mask:0xf
    v_mov_b32_dpp v233, v117 row_newbcast:0 row_mask:0xf bank_mask:0xf
    v_mov_b32_dpp v230, v98 row_newbcast:0 row_mask:0xf bank_mask:0xf
    v_mov_b32_dpp v234, v118 row_newbcast:0 row_mask:0xf bank_mask:0xf
    v_mov_b32_dpp v231, v99 row_newbcast:0 row_mask:0xf bank_mask:0xf
    v_mov_b32_dpp v235, v119 row_newbcast:0 row_mask:0xf bank_mask:0xf
    v_mov_b32 v236, v136
    v_mov_b32 v237, v136
    s_nop 1
    v_permlane16_swap_b32 v236, v237
    v_mov_b32 v237, v236
    s_nop 1
    v_permlane32_swap_b32 v236, v237
    v_mov_b32 v237, v236
    s_waitcnt lgkmcnt(10)
    v_pk_mul_f32 v[140:141], v[232:233], v[24:25] op_sel:[0,1] op_sel_hi:[1,1]
    v_pk_mul_f32 v[142:143], v[234:235], v[24:25] op_sel:[0,1] op_sel_hi:[1,1]
    v_pk_fma_f32 v[116:117], v[116:117], v[24:25], v[140:141] op_sel:[0,0,0] op_sel_hi:[1,0,1]
    v_pk_fma_f32 v[118:119], v[118:119], v[24:25], v[142:143] op_sel:[0,0,0] op_sel_hi:[1,0,1]
    v_cvt_pk_bf16_f32 v192, v116, v117
    v_cvt_pk_bf16_f32 v193, v118, v119
    v_pk_mul_f32 v[140:141], v[232:233], v[16:17] op_sel:[0,1] op_sel_hi:[1,1]
    v_pk_mul_f32 v[142:143], v[234:235], v[16:17] op_sel:[0,1] op_sel_hi:[1,1]
    v_pk_fma_f32 v[100:101], v[100:101], v[16:17], v[140:141] op_sel:[0,0,0] op_sel_hi:[1,0,1]
    v_pk_fma_f32 v[102:103], v[102:103], v[16:17], v[142:143] op_sel:[0,0,0] op_sel_hi:[1,0,1]
    v_cvt_pk_bf16_f32 v184, v100, v101
    v_cvt_pk_bf16_f32 v185, v102, v103
    v_pk_mul_f32 v[240:241], v[228:229], v[16:17] op_sel:[0,1] op_sel_hi:[1,1]
    v_pk_mul_f32 v[242:243], v[230:231], v[16:17] op_sel:[0,1] op_sel_hi:[1,1]
    v_pk_fma_f32 v[80:81], v[80:81], v[16:17], v[240:241] op_sel:[0,0,0] op_sel_hi:[1,0,1]
    v_pk_fma_f32 v[82:83], v[82:83], v[16:17], v[242:243] op_sel:[0,0,0] op_sel_hi:[1,0,1]
    v_cvt_pk_bf16_f32 v176, v80, v81
    v_cvt_pk_bf16_f32 v177, v82, v83
    v_pk_mul_f32 v[140:141], v[232:233], v[18:19] op_sel:[0,1] op_sel_hi:[1,1]
    v_pk_mul_f32 v[142:143], v[234:235], v[18:19] op_sel:[0,1] op_sel_hi:[1,1]
    v_pk_fma_f32 v[104:105], v[104:105], v[18:19], v[140:141] op_sel:[0,0,0] op_sel_hi:[1,0,1]
    v_pk_fma_f32 v[106:107], v[106:107], v[18:19], v[142:143] op_sel:[0,0,0] op_sel_hi:[1,0,1]
    v_cvt_pk_bf16_f32 v186, v104, v105
    v_cvt_pk_bf16_f32 v187, v106, v107
    v_pk_mul_f32 v[240:241], v[228:229], v[18:19] op_sel:[0,1] op_sel_hi:[1,1]
    v_pk_mul_f32 v[242:243], v[230:231], v[18:19] op_sel:[0,1] op_sel_hi:[1,1]
    v_pk_fma_f32 v[84:85], v[84:85], v[18:19], v[240:241] op_sel:[0,0,0] op_sel_hi:[1,0,1]
    v_pk_fma_f32 v[86:87], v[86:87], v[18:19], v[242:243] op_sel:[0,0,0] op_sel_hi:[1,0,1]
    v_cvt_pk_bf16_f32 v178, v84, v85
    v_cvt_pk_bf16_f32 v179, v86, v87
    v_pk_mul_f32 v[140:141], v[232:233], v[20:21] op_sel:[0,1] op_sel_hi:[1,1]
    v_pk_mul_f32 v[142:143], v[234:235], v[20:21] op_sel:[0,1] op_sel_hi:[1,1]
    v_pk_fma_f32 v[108:109], v[108:109], v[20:21], v[140:141] op_sel:[0,0,0] op_sel_hi:[1,0,1]
    v_pk_fma_f32 v[110:111], v[110:111], v[20:21], v[142:143] op_sel:[0,0,0] op_sel_hi:[1,0,1]
    v_cvt_pk_bf16_f32 v188, v108, v109
    v_cvt_pk_bf16_f32 v189, v110, v111
    v_pk_mul_f32 v[240:241], v[228:229], v[20:21] op_sel:[0,1] op_sel_hi:[1,1]
    v_pk_mul_f32 v[242:243], v[230:231], v[20:21] op_sel:[0,1] op_sel_hi:[1,1]
    v_pk_fma_f32 v[88:89], v[88:89], v[20:21], v[240:241] op_sel:[0,0,0] op_sel_hi:[1,0,1]
    v_pk_fma_f32 v[90:91], v[90:91], v[20:21], v[242:243] op_sel:[0,0,0] op_sel_hi:[1,0,1]
    v_cvt_pk_bf16_f32 v180, v88, v89
    v_cvt_pk_bf16_f32 v181, v90, v91
    v_pk_mul_f32 v[140:141], v[232:233], v[22:23] op_sel:[0,1] op_sel_hi:[1,1]
    v_pk_mul_f32 v[142:143], v[234:235], v[22:23] op_sel:[0,1] op_sel_hi:[1,1]
    v_pk_fma_f32 v[112:113], v[112:113], v[22:23], v[140:141] op_sel:[0,0,0] op_sel_hi:[1,0,1]
    v_pk_fma_f32 v[114:115], v[114:115], v[22:23], v[142:143] op_sel:[0,0,0] op_sel_hi:[1,0,1]
    v_cvt_pk_bf16_f32 v190, v112, v113
    v_cvt_pk_bf16_f32 v191, v114, v115
    v_pk_mul_f32 v[240:241], v[228:229], v[22:23] op_sel:[0,1] op_sel_hi:[1,1]
    v_pk_mul_f32 v[242:243], v[230:231], v[22:23] op_sel:[0,1] op_sel_hi:[1,1]
    v_pk_fma_f32 v[92:93], v[92:93], v[22:23], v[240:241] op_sel:[0,0,0] op_sel_hi:[1,0,1]
    v_pk_fma_f32 v[94:95], v[94:95], v[22:23], v[242:243] op_sel:[0,0,0] op_sel_hi:[1,0,1]
    v_cvt_pk_bf16_f32 v182, v92, v93
    v_cvt_pk_bf16_f32 v183, v94, v95
    s_waitcnt lgkmcnt(8)
    v_pk_mul_f32 v[240:241], v[208:209], v[236:237]
    v_pk_mul_f32 v[242:243], v[210:211], v[236:237]
    v_pk_fma_f32 v[120:121], v[120:121], v[28:29], v[240:241]
    v_pk_fma_f32 v[122:123], v[122:123], v[30:31], v[242:243]
    s_waitcnt lgkmcnt(6)
    v_pk_mul_f32 v[140:141], v[212:213], v[236:237]
    v_pk_mul_f32 v[142:143], v[214:215], v[236:237]
    v_pk_fma_f32 v[124:125], v[124:125], v[32:33], v[140:141]
    v_pk_fma_f32 v[126:127], v[126:127], v[34:35], v[142:143]
    s_waitcnt lgkmcnt(4)
    v_pk_mul_f32 v[240:241], v[216:217], v[236:237]
    v_pk_mul_f32 v[242:243], v[218:219], v[236:237]
    v_pk_fma_f32 v[128:129], v[128:129], v[36:37], v[240:241]
    v_pk_fma_f32 v[130:131], v[130:131], v[38:39], v[242:243]
    s_waitcnt lgkmcnt(2)
    v_pk_mul_f32 v[140:141], v[220:221], v[236:237]
    v_pk_mul_f32 v[142:143], v[222:223], v[236:237]
    v_pk_fma_f32 v[132:133], v[132:133], v[40:41], v[140:141]
    v_pk_fma_f32 v[134:135], v[134:135], v[42:43], v[142:143]
    s_waitcnt lgkmcnt(0)
    v_pk_mul_f32 v[240:241], v[224:225], v[236:237]
    v_pk_mul_f32 v[242:243], v[226:227], v[236:237]
    v_pk_fma_f32 v[136:137], v[136:137], v[44:45], v[240:241]
    v_pk_fma_f32 v[138:139], v[138:139], v[46:47], v[242:243]
    v_mfma_f32_16x16x16_bf16 v[80:83], v[184:185], v[176:177], v[160:163]
    v_cvt_pk_bf16_f32 v198, v120, v121
    v_cvt_pk_bf16_f32 v199, v122, v123
    v_mfma_f32_16x16x16_bf16 v[84:87], v[192:193], v[176:177], v[168:171]
    v_cvt_pk_bf16_f32 v202, v124, v125
    v_cvt_pk_bf16_f32 v203, v126, v127
    v_mfma_f32_16x16x16_bf16 v[88:91], v[186:187], v[178:179], v[160:163]
    v_cvt_pk_bf16_f32 v196, v128, v129
    v_cvt_pk_bf16_f32 v197, v130, v131
    v_mfma_f32_16x16x16_bf16 v[92:95], v[192:193], v[178:179], v[172:175]
    v_cvt_pk_bf16_f32 v204, v132, v133
    v_cvt_pk_bf16_f32 v205, v134, v135
    v_mfma_f32_16x16x16_bf16 v[96:99], v[188:189], v[180:181], v[160:163]
    v_cvt_pk_bf16_f32 v200, v136, v137
    v_cvt_pk_bf16_f32 v201, v138, v139
    v_mfma_f32_16x16x16_bf16 v[100:103], v[184:185], v[180:181], v[164:167]
    v_mov_b32 v244, s48
    v_mov_b32 v245, s48
    v_mfma_f32_16x16x16_bf16 v[104:107], v[190:191], v[182:183], v[160:163]
    v_mov_b32 v246, s48
    v_mov_b32 v247, s48
    v_mfma_f32_16x16x16_bf16 v[108:111], v[186:187], v[182:183], v[164:167]
    s_mov_b32 s50, 0x3eb8aa3b
    v_max3_f32 v16, v80, v81, v82
    v_max3_f32 v20, v83, v84, v85
    v_max3_f32 v17, v88, v89, v90
    v_max3_f32 v21, v91, v92, v93
    v_max3_f32 v18, v96, v97, v98
    v_max3_f32 v22, v99, v100, v101
    v_max3_f32 v19, v104, v105, v106
    v_max3_f32 v23, v107, v108, v109
    v_max3_f32 v16, v16, v86, v87
    v_max3_f32 v17, v17, v94, v95
    v_max3_f32 v18, v18, v102, v103
    v_max3_f32 v19, v19, v110, v111
    v_max_f32 v16, v16, v20
    v_max_f32 v17, v17, v21
    v_max_f32 v18, v18, v22
    v_max_f32 v19, v19, v23
    v_permlane16_swap_b32 v16, v17
    s_nop 0
    v_permlane16_swap_b32 v18, v19
    v_max_f32 v16, v16, v17
    v_max_f32 v18, v18, v19
    s_nop 1
    v_permlane32_swap_b32 v16, v18
    v_max_f32 v16, v16, v18
    v_mul_f32 v16, s50, v16
    v_mov_b32 v18, v16
    s_nop 1
    v_permlane32_swap_b32 v16, v18
    v_mov_b32 v17, v16
    v_mov_b32 v19, v18
    s_nop 0
    v_permlane16_swap_b32 v16, v17
    v_permlane16_swap_b32 v18, v19
    v_fma_f32 v80, v80, s50, -v16
    v_fma_f32 v81, v81, s50, -v16
    v_fma_f32 v82, v82, s50, -v16
    v_fma_f32 v83, v83, s50, -v16
    v_fma_f32 v84, v84, s50, -v16
    v_fma_f32 v85, v85, s50, -v16
    v_fma_f32 v86, v86, s50, -v16
    v_fma_f32 v87, v87, s50, -v16
    v_exp_f32 v80, v80
    v_exp_f32 v81, v81
    v_exp_f32 v82, v82
    v_exp_f32 v83, v83
    v_exp_f32 v84, v84
    v_exp_f32 v85, v85
    v_exp_f32 v86, v86
    v_exp_f32 v87, v87
    v_cvt_pk_bf16_f32 v32, v80, v81
    v_cvt_pk_bf16_f32 v33, v82, v83
    v_cvt_pk_bf16_f32 v34, v84, v85
    v_cvt_pk_bf16_f32 v35, v86, v87
    s_nop 1
    v_mfma_f32_16x16x32_bf16 v[208:211], v[244:247], v[32:35], 0
    v_mfma_f32_16x16x32_bf16 v[48:51], v[198:201], v[32:35], 0
    v_fma_f32 v88, v88, s50, -v17
    v_fma_f32 v89, v89, s50, -v17
    v_fma_f32 v90, v90, s50, -v17
    v_fma_f32 v91, v91, s50, -v17
    v_fma_f32 v92, v92, s50, -v17
    v_fma_f32 v93, v93, s50, -v17
    v_fma_f32 v94, v94, s50, -v17
    v_fma_f32 v95, v95, s50, -v17
    v_exp_f32 v88, v88
    v_exp_f32 v89, v89
    v_exp_f32 v90, v90
    v_exp_f32 v91, v91
    v_exp_f32 v92, v92
    v_exp_f32 v93, v93
    v_exp_f32 v94, v94
    v_exp_f32 v95, v95
    v_cvt_pk_bf16_f32 v36, v92, v93
    v_cvt_pk_bf16_f32 v37, v94, v95
    v_cvt_pk_bf16_f32 v38, v88, v89
    v_cvt_pk_bf16_f32 v39, v90, v91
    v_rcp_f32 v208, v208
    s_nop 0
    v_mfma_f32_16x16x32_bf16 v[212:215], v[244:247], v[36:39], 0
    v_mfma_f32_16x16x32_bf16 v[52:55], v[200:203], v[36:39], 0
    v_fma_f32 v96, v96, s50, -v18
    v_fma_f32 v97, v97, s50, -v18
    v_fma_f32 v98, v98, s50, -v18
    v_fma_f32 v99, v99, s50, -v18
    v_fma_f32 v100, v100, s50, -v18
    v_fma_f32 v101, v101, s50, -v18
    v_fma_f32 v102, v102, s50, -v18
    v_fma_f32 v103, v103, s50, -v18
    v_exp_f32 v96, v96
    v_exp_f32 v97, v97
    v_exp_f32 v98, v98
    v_exp_f32 v99, v99
    v_exp_f32 v100, v100
    v_exp_f32 v101, v101
    v_exp_f32 v102, v102
    v_exp_f32 v103, v103
    v_cvt_pk_bf16_f32 v40, v96, v97
    v_cvt_pk_bf16_f32 v41, v98, v99
    v_cvt_pk_bf16_f32 v42, v100, v101
    v_cvt_pk_bf16_f32 v43, v102, v103
    v_rcp_f32 v212, v212
    s_nop 0
    v_mfma_f32_16x16x32_bf16 v[216:219], v[244:247], v[40:43], 0
    v_mfma_f32_16x16x32_bf16 v[56:59], v[196:199], v[40:43], 0
    v_fma_f32 v104, v104, s50, -v19
    v_fma_f32 v105, v105, s50, -v19
    v_fma_f32 v106, v106, s50, -v19
    v_fma_f32 v107, v107, s50, -v19
    v_fma_f32 v108, v108, s50, -v19
    v_fma_f32 v109, v109, s50, -v19
    v_fma_f32 v110, v110, s50, -v19
    v_fma_f32 v111, v111, s50, -v19
    v_exp_f32 v104, v104
    v_exp_f32 v105, v105
    v_exp_f32 v106, v106
    v_exp_f32 v107, v107
    v_exp_f32 v108, v108
    v_exp_f32 v109, v109
    v_exp_f32 v110, v110
    v_exp_f32 v111, v111
    v_cvt_pk_bf16_f32 v44, v108, v109
    v_cvt_pk_bf16_f32 v45, v110, v111
    v_cvt_pk_bf16_f32 v46, v104, v105
    v_cvt_pk_bf16_f32 v47, v106, v107
    v_rcp_f32 v216, v216
    s_nop 0
    v_mfma_f32_16x16x32_bf16 v[220:223], v[244:247], v[44:47], 0
    v_mfma_f32_16x16x32_bf16 v[60:63], v[202:205], v[44:47], 0
    v_pk_mul_f32 v[48:49], v[48:49], v[208:209] op_sel:[0,0] op_sel_hi:[1,0]
    v_pk_mul_f32 v[50:51], v[50:51], v[208:209] op_sel:[0,0] op_sel_hi:[1,0]
    v_cvt_pk_bf16_f32 v64, v48, v49
    v_cvt_pk_bf16_f32 v65, v50, v51
    v_pk_mul_f32 v[52:53], v[52:53], v[212:213] op_sel:[0,0] op_sel_hi:[1,0]
    v_pk_mul_f32 v[54:55], v[54:55], v[212:213] op_sel:[0,0] op_sel_hi:[1,0]
    v_cvt_pk_bf16_f32 v66, v52, v53
    v_cvt_pk_bf16_f32 v67, v54, v55
    v_pk_mul_f32 v[56:57], v[56:57], v[216:217] op_sel:[0,0] op_sel_hi:[1,0]
    v_pk_mul_f32 v[58:59], v[58:59], v[216:217] op_sel:[0,0] op_sel_hi:[1,0]
    v_cvt_pk_bf16_f32 v68, v56, v57
    v_cvt_pk_bf16_f32 v69, v58, v59
    v_permlane32_swap_b32 v64, v66
    v_permlane32_swap_b32 v65, v67
    v_rcp_f32 v220, v220
    s_nop 0
    v_pk_mul_f32 v[60:61], v[60:61], v[220:221] op_sel:[0,0] op_sel_hi:[1,0]
    v_pk_mul_f32 v[62:63], v[62:63], v[220:221] op_sel:[0,0] op_sel_hi:[1,0]
    v_cvt_pk_bf16_f32 v70, v60, v61
    v_cvt_pk_bf16_f32 v71, v62, v63
    s_nop 0
    v_permlane32_swap_b32 v68, v70
    v_permlane32_swap_b32 v69, v71
    buffer_store_dwordx4 v[64:67], v13, s[24:27], s93 offen sc1
    buffer_store_dwordx4 v[68:71], v13, s[24:27], s94 offen sc1
A_ST1_DONE:
    v_add_u32 v2, 0, v150
    v_mov_b32 v3, v151
    s_lshl_b32 s50, s47, 2
    s_add_u32 s50, s50, s44
    s_lshl_b32 s50, s50, 3
    s_add_u32 s50, s50, 643072
    v_mov_b32 v4, s50
    s_waitcnt vmcnt(0)
    s_mov_b64 exec, 1
    s_cmp_lg_u32 s49, 0
    s_cbranch_scc1 A_SIG0_SLOW
    buffer_store_dwordx2 v[2:3], v4, s[24:27], 0 offen
    s_branch A_SIG0_DONE
A_SIG0_SLOW:
    buffer_store_dwordx2 v[2:3], v4, s[24:27], 0 offen sc1
A_SIG0_DONE:
    s_mov_b64 exec, -1
    s_barrier
    ds_read_b64_tr_b16 v[160:161], v149 offset:49152
    ds_read_b64_tr_b16 v[162:163], v149 offset:49920
    ds_read_b64_tr_b16 v[164:165], v152 offset:49152
    ds_read_b64_tr_b16 v[166:167], v152 offset:49920
    ds_read_b64_tr_b16 v[168:169], v149 offset:50688
    ds_read_b64_tr_b16 v[170:171], v149 offset:51456
    ds_read_b64_tr_b16 v[172:173], v152 offset:50688
    ds_read_b64_tr_b16 v[174:175], v152 offset:51456
    ds_read_b64_tr_b16 v[176:177], v149 offset:55296
    ds_read_b64_tr_b16 v[178:179], v149 offset:56064
    ds_read_b64_tr_b16 v[180:181], v152 offset:55296
    ds_read_b64_tr_b16 v[182:183], v152 offset:56064
    ds_read_b64_tr_b16 v[184:185], v149 offset:56832
    ds_read_b64_tr_b16 v[186:187], v149 offset:57600
    ds_read_b64_tr_b16 v[188:189], v152 offset:56832
    ds_read_b64_tr_b16 v[190:191], v152 offset:57600
    v_lshrrev_b32 v2, 4, v0
    v_xor_b32 v2, v2, v0
    v_and_b32 v2, 1, v2
    v_cmp_eq_u32 vcc, 0, v2
    v_mov_b32 v3, s48
    s_nop 0
    v_cndmask_b32 v120, 0, v3, vcc
    v_cndmask_b32 v121, 0, v3, vcc
    v_cndmask_b32 v122, 0, v3, vcc
    v_cndmask_b32 v123, 0, v3, vcc
    v_mov_b64 v[112:113], 0
    v_mov_b64 v[114:115], 0
    v_mov_b64 v[116:117], 0
    v_mov_b64 v[118:119], 0
    s_waitcnt lgkmcnt(14)
    v_mfma_f32_16x16x32_bf16 v[112:115], v[160:163], v[120:123], v[112:115]
    ds_read_b64_tr_b16 v[192:193], v149 offset:0
    ds_read_b64_tr_b16 v[194:195], v149 offset:768
    s_waitcnt lgkmcnt(14)
    v_mfma_f32_16x16x32_bf16 v[116:119], v[164:167], v[120:123], v[116:119]
    ds_read_b64_tr_b16 v[196:197], v152 offset:0
    ds_read_b64_tr_b16 v[198:199], v152 offset:768
    s_waitcnt lgkmcnt(14)
    v_mfma_f32_16x16x32_bf16 v[112:115], v[168:171], v[120:123], v[112:115]
    ds_read_b64_tr_b16 v[200:201], v149 offset:1536
    ds_read_b64_tr_b16 v[202:203], v149 offset:2304
    s_waitcnt lgkmcnt(14)
    v_mfma_f32_16x16x32_bf16 v[116:119], v[172:175], v[120:123], v[116:119]
    ds_read_b64_tr_b16 v[204:205], v152 offset:1536
    ds_read_b64_tr_b16 v[206:207], v152 offset:2304
    s_waitcnt lgkmcnt(14)
    v_mfma_f32_16x16x32_bf16 v[112:115], v[176:179], v[120:123], v[112:115]
    ds_read_b64_tr_b16 v[208:209], v149 offset:6144
    ds_read_b64_tr_b16 v[210:211], v149 offset:6912
    s_waitcnt lgkmcnt(14)
    v_mfma_f32_16x16x32_bf16 v[116:119], v[180:183], v[120:123], v[116:119]
    ds_read_b64_tr_b16 v[212:213], v152 offset:6144
    ds_read_b64_tr_b16 v[214:215], v152 offset:6912
    s_waitcnt lgkmcnt(14)
    v_mfma_f32_16x16x32_bf16 v[112:115], v[184:187], v[120:123], v[112:115]
    ds_read_b64_tr_b16 v[216:217], v149 offset:7680
    ds_read_b64_tr_b16 v[218:219], v149 offset:8448
    s_waitcnt lgkmcnt(14)
    v_mfma_f32_16x16x32_bf16 v[116:119], v[188:191], v[120:123], v[116:119]
    ds_read_b64_tr_b16 v[220:221], v152 offset:7680
    ds_read_b64_tr_b16 v[222:223], v152 offset:8448
    s_waitcnt lgkmcnt(14)
    v_mfma_f32_16x16x32_bf16 v[112:115], v[192:195], v[120:123], v[112:115]
    s_waitcnt lgkmcnt(12)
    v_mfma_f32_16x16x32_bf16 v[116:119], v[196:199], v[120:123], v[116:119]
    s_waitcnt lgkmcnt(10)
    v_mfma_f32_16x16x32_bf16 v[112:115], v[200:203], v[120:123], v[112:115]
    s_waitcnt lgkmcnt(8)
    v_mfma_f32_16x16x32_bf16 v[116:119], v[204:207], v[120:123], v[116:119]
    s_waitcnt lgkmcnt(6)
    v_mfma_f32_16x16x32_bf16 v[112:115], v[208:211], v[120:123], v[112:115]
    s_waitcnt lgkmcnt(4)
    v_mfma_f32_16x16x32_bf16 v[116:119], v[212:215], v[120:123], v[116:119]
    s_waitcnt lgkmcnt(2)
    v_mfma_f32_16x16x32_bf16 v[112:115], v[216:219], v[120:123], v[112:115]
    s_waitcnt lgkmcnt(0)
    v_mfma_f32_16x16x32_bf16 v[116:119], v[220:223], v[120:123], v[116:119]
    v_and_b32 v4, 31, v0
    s_and_b32 s50, s47, 8
    s_lshl_b32 s50, s50, 2
    v_add_u32 v4, s50, v4
    v_lshlrev_b32 v4, 3, v4
    v_add_u32 v2, 0, v150
    v_mov_b32 v3, v151
    s_mov_b32 s57, 0
    s_mov_b32 s50, 643072
POLL0:
    buffer_load_dwordx2 v[6:7], v4, s[24:27], s50 offen sc1
    s_add_u32 s57, s57, 1
    s_waitcnt vmcnt(0)
    v_cmp_ne_u64 vcc, v[6:7], v[2:3]
    s_cmp_ge_u32 s57, 20000
    s_cbranch_scc1 POLL0_DONE
    s_cbranch_vccnz POLL0
POLL0_DONE:
    s_add_u32 m0, s99, 0
    s_nop 0
    buffer_load_dwordx4 v8, s[24:27], s60 offen sc1 lds
    s_add_u32 m0, s99, 32768
    s_nop 0
    buffer_load_dwordx4 v9, s[24:27], s60 offen sc1 lds
    s_add_u32 m0, s99, 4096
    s_nop 0
    buffer_load_dwordx4 v8, s[24:27], s61 offen sc1 lds
    s_add_u32 m0, s99, 36864
    s_nop 0
    buffer_load_dwordx4 v9, s[24:27], s61 offen sc1 lds
    s_add_u32 m0, s99, 8192
    s_nop 0
    buffer_load_dwordx4 v8, s[24:27], s62 offen sc1 lds
    s_add_u32 m0, s99, 40960
    s_nop 0
    buffer_load_dwordx4 v9, s[24:27], s62 offen sc1 lds
    s_add_u32 m0, s99, 12288
    s_nop 0
    buffer_load_dwordx4 v8, s[24:27], s63 offen sc1 lds
    s_add_u32 m0, s99, 45056
    s_nop 0
    buffer_load_dwordx4 v9, s[24:27], s63 offen sc1 lds
    s_waitcnt vmcnt(4)
    s_barrier
    s_add_u32 m0, s99, 16384
    s_nop 0
    buffer_load_dwordx4 v8, s[24:27], s86 offen sc1 lds
    s_add_u32 m0, s99, 49152
    s_nop 0
    buffer_load_dwordx4 v9, s[24:27], s86 offen sc1 lds
    s_add_u32 m0, s99, 20480
    s_nop 0
    buffer_load_dwordx4 v8, s[24:27], s58 offen sc1 lds
    s_add_u32 m0, s99, 53248
    s_nop 0
    buffer_load_dwordx4 v9, s[24:27], s58 offen sc1 lds
    s_waitcnt vmcnt(4)
    s_barrier
    s_add_u32 m0, s99, 24576
    s_nop 0
    buffer_load_dwordx4 v8, s[24:27], s59 offen sc1 lds
    s_add_u32 m0, s99, 57344
    s_nop 0
    buffer_load_dwordx4 v9, s[24:27], s59 offen sc1 lds
    s_add_u32 m0, s99, 28672
    s_nop 0
    buffer_load_dwordx4 v8, s[24:27], s101 offen sc1 lds
    s_add_u32 m0, s99, 61440
    s_nop 0
    buffer_load_dwordx4 v9, s[24:27], s101 offen sc1 lds
    s_waitcnt vmcnt(4)
    s_barrier
    s_waitcnt vmcnt(0)
    s_barrier
    s_xor_b32 s56, s88, 4
    s_mul_i32 s56, s56, 176128
    s_add_u32 s56, s56, s90
    s_add_u32 m0, s89, 106496
    s_add_u32 s87, s56, 44032
    buffer_load_dwordx4 v155, s[32:35], s56 offen lds
    buffer_load_dwordx4 v156, s[32:35], s56 offen offset:1024 lds
    buffer_load_dwordx4 v157, s[32:35], s56 offen offset:2048 lds
    s_add_u32 m0, s89, 109568
    s_nop 0
    buffer_load_dwordx4 v155, s[32:35], s87 offen lds
    buffer_load_dwordx4 v156, s[32:35], s87 offen offset:1024 lds
    buffer_load_dwordx4 v157, s[32:35], s87 offen offset:2048 lds
    s_xor_b32 s56, s88, 5
    s_mul_i32 s56, s56, 176128
    s_add_u32 s56, s56, s90
    s_add_u32 m0, s89, 131072
    s_add_u32 s87, s56, 44032
    buffer_load_dwordx4 v155, s[32:35], s56 offen lds
    buffer_load_dwordx4 v156, s[32:35], s56 offen offset:1024 lds
    buffer_load_dwordx4 v157, s[32:35], s56 offen offset:2048 lds
    s_add_u32 m0, s89, 134144
    s_nop 0
    buffer_load_dwordx4 v155, s[32:35], s87 offen lds
    buffer_load_dwordx4 v156, s[32:35], s87 offen offset:1024 lds
    buffer_load_dwordx4 v157, s[32:35], s87 offen offset:2048 lds
    s_waitcnt vmcnt(6)
    s_barrier
    s_lshl_b32 s54, s47, 2
    s_add_u32 s54, s54, s44
    s_cmp_lt_u32 s54, 58
    s_cbranch_scc1 A_P3GO
    s_waitcnt vmcnt(0)
    s_barrier
    s_barrier
    s_barrier
    s_barrier
    s_barrier
    s_barrier
    s_barrier
    s_branch A_ST3Z_DONE
A_P3GO:
    ds_read_b128 v[124:127], v153 offset:0
    ds_read_b128 v[128:131], v153 offset:4096
    ds_read_b128 v[132:135], v154 offset:0
    ds_read_b128 v[136:139], v154 offset:4096
    s_waitcnt lgkmcnt(3)
    v_mfma_f32_32x32x16_bf16 v[16:31], v[160:163], v[124:127], 0
    ds_read_b128 v[140:143], v153 offset:1024
    ds_read_b64_tr_b16 v[224:225], v149 offset:24576
    v_mfma_f32_32x32x16_bf16 v[80:95], v[164:167], v[124:127], 0
    ds_read_b64_tr_b16 v[226:227], v149 offset:25344
    s_waitcnt lgkmcnt(5)
    v_mfma_f32_32x32x16_bf16 v[32:47], v[160:163], v[128:131], 0
    ds_read_b128 v[144:147], v153 offset:5120
    ds_read_b64_tr_b16 v[228:229], v152 offset:24576
    v_mfma_f32_32x32x16_bf16 v[96:111], v[164:167], v[128:131], 0
    ds_read_b64_tr_b16 v[230:231], v152 offset:25344
    s_waitcnt lgkmcnt(7)
    v_mfma_f32_32x32x16_bf16 v[48:63], v[160:163], v[132:135], 0
    ds_read_b128 v[124:127], v154 offset:1024
    ds_read_b64_tr_b16 v[232:233], v149 offset:26112
    s_waitcnt lgkmcnt(8)
    v_mfma_f32_32x32x16_bf16 v[64:79], v[160:163], v[136:139], 0
    ds_read_b128 v[128:131], v154 offset:5120
    ds_read_b64_tr_b16 v[234:235], v149 offset:26880
    s_waitcnt lgkmcnt(9)
    v_mfma_f32_32x32x16_bf16 v[16:31], v[168:171], v[140:143], v[16:31]
    ds_read_b128 v[132:135], v153 offset:2048
    ds_read_b64_tr_b16 v[236:237], v152 offset:26112
    v_mfma_f32_32x32x16_bf16 v[80:95], v[172:175], v[140:143], v[80:95]
    ds_read_b64_tr_b16 v[238:239], v152 offset:26880
    s_waitcnt lgkmcnt(9)
    v_mfma_f32_32x32x16_bf16 v[32:47], v[168:171], v[144:147], v[32:47]
    ds_read_b128 v[136:139], v153 offset:6144
    ds_read_b64_tr_b16 v[240:241], v149 offset:30720
    v_mfma_f32_32x32x16_bf16 v[96:111], v[172:175], v[144:147], v[96:111]
    ds_read_b64_tr_b16 v[242:243], v149 offset:31488
    s_waitcnt lgkmcnt(9)
    v_mfma_f32_32x32x16_bf16 v[48:63], v[168:171], v[124:127], v[48:63]
    ds_read_b128 v[140:143], v154 offset:2048
    ds_read_b64_tr_b16 v[244:245], v152 offset:30720
    s_waitcnt lgkmcnt(9)
    v_mfma_f32_32x32x16_bf16 v[64:79], v[168:171], v[128:131], v[64:79]
    ds_read_b128 v[144:147], v154 offset:6144
    ds_read_b64_tr_b16 v[246:247], v152 offset:31488
    v_mfma_f32_16x16x32_bf16 v[112:115], v[224:227], v[120:123], v[112:115]
    v_mfma_f32_16x16x32_bf16 v[116:119], v[228:231], v[120:123], v[116:119]
    s_waitcnt lgkmcnt(9)
    v_mfma_f32_32x32x16_bf16 v[16:31], v[176:179], v[132:135], v[16:31]
    ds_read_b128 v[124:127], v153 offset:3072
    ds_read_b64_tr_b16 v[248:249], v149 offset:32256
    v_mfma_f32_32x32x16_bf16 v[80:95], v[180:183], v[132:135], v[80:95]
    ds_read_b64_tr_b16 v[250:251], v149 offset:33024
    s_waitcnt lgkmcnt(9)
    v_mfma_f32_32x32x16_bf16 v[32:47], v[176:179], v[136:139], v[32:47]
    ds_read_b128 v[128:131], v153 offset:7168
    ds_read_b64_tr_b16 v[252:253], v152 offset:32256
    v_mfma_f32_32x32x16_bf16 v[96:111], v[180:183], v[136:139], v[96:111]
    ds_read_b64_tr_b16 v[254:255], v152 offset:33024
    s_waitcnt lgkmcnt(9)
    v_mfma_f32_32x32x16_bf16 v[48:63], v[176:179], v[140:143], v[48:63]
    ds_read_b128 v[132:135], v154 offset:3072
    s_waitcnt lgkmcnt(8)
    v_mfma_f32_32x32x16_bf16 v[64:79], v[176:179], v[144:147], v[64:79]
    ds_read_b128 v[136:139], v154 offset:7168
    v_mfma_f32_16x16x32_bf16 v[112:115], v[232:235], v[120:123], v[112:115]
    v_mfma_f32_16x16x32_bf16 v[116:119], v[236:239], v[120:123], v[116:119]
    v_mfma_f32_16x16x32_bf16 v[112:115], v[240:243], v[120:123], v[112:115]
    s_waitcnt lgkmcnt(8)
    v_mfma_f32_16x16x32_bf16 v[116:119], v[244:247], v[120:123], v[116:119]
    s_waitcnt vmcnt(0)
    s_waitcnt lgkmcnt(0)
    s_barrier
    v_mfma_f32_32x32x16_bf16 v[16:31], v[184:187], v[124:127], v[16:31]
    ds_read_b128 v[140:143], v153 offset:16384
    v_mfma_f32_32x32x16_bf16 v[80:95], v[188:191], v[124:127], v[80:95]
    v_mfma_f32_32x32x16_bf16 v[32:47], v[184:187], v[128:131], v[32:47]
    ds_read_b128 v[144:147], v153 offset:20480
    v_mfma_f32_32x32x16_bf16 v[96:111], v[188:191], v[128:131], v[96:111]
    v_mfma_f32_32x32x16_bf16 v[48:63], v[184:187], v[132:135], v[48:63]
    ds_read_b128 v[124:127], v154 offset:16384
    v_mfma_f32_32x32x16_bf16 v[64:79], v[184:187], v[136:139], v[64:79]
    ds_read_b128 v[128:131], v154 offset:20480
    v_mfma_f32_16x16x32_bf16 v[112:115], v[248:251], v[120:123], v[112:115]
    v_mfma_f32_16x16x32_bf16 v[116:119], v[252:255], v[120:123], v[116:119]
    s_waitcnt lgkmcnt(3)
    v_mfma_f32_32x32x16_bf16 v[16:31], v[192:195], v[140:143], v[16:31]
    ds_read_b128 v[132:135], v153 offset:17408
    ds_read_b64_tr_b16 v[160:161], v149 offset:49152
    v_mfma_f32_32x32x16_bf16 v[80:95], v[196:199], v[140:143], v[80:95]
    ds_read_b64_tr_b16 v[162:163], v149 offset:49920
    s_waitcnt lgkmcnt(5)
    v_mfma_f32_32x32x16_bf16 v[32:47], v[192:195], v[144:147], v[32:47]
    ds_read_b128 v[136:139], v153 offset:21504
    ds_read_b64_tr_b16 v[164:165], v152 offset:49152
    v_mfma_f32_32x32x16_bf16 v[96:111], v[196:199], v[144:147], v[96:111]
    ds_read_b64_tr_b16 v[166:167], v152 offset:49920
    s_waitcnt lgkmcnt(7)
    v_mfma_f32_32x32x16_bf16 v[48:63], v[192:195], v[124:127], v[48:63]
    ds_read_b128 v[140:143], v154 offset:17408
    ds_read_b64_tr_b16 v[168:169], v149 offset:50688
    s_waitcnt lgkmcnt(8)
    v_mfma_f32_32x32x16_bf16 v[64:79], v[192:195], v[128:131], v[64:79]
    ds_read_b128 v[144:147], v154 offset:21504
    ds_read_b64_tr_b16 v[170:171], v149 offset:51456
    s_waitcnt lgkmcnt(9)
    v_mfma_f32_32x32x16_bf16 v[16:31], v[200:203], v[132:135], v[16:31]
    ds_read_b128 v[124:127], v153 offset:18432
    ds_read_b64_tr_b16 v[172:173], v152 offset:50688
    v_mfma_f32_32x32x16_bf16 v[80:95], v[204:207], v[132:135], v[80:95]
    ds_read_b64_tr_b16 v[174:175], v152 offset:51456
    s_waitcnt lgkmcnt(9)
    v_mfma_f32_32x32x16_bf16 v[32:47], v[200:203], v[136:139], v[32:47]
    ds_read_b128 v[128:131], v153 offset:22528
    ds_read_b64_tr_b16 v[176:177], v149 offset:55296
    v_mfma_f32_32x32x16_bf16 v[96:111], v[204:207], v[136:139], v[96:111]
    ds_read_b64_tr_b16 v[178:179], v149 offset:56064
    s_waitcnt lgkmcnt(9)
    v_mfma_f32_32x32x16_bf16 v[48:63], v[200:203], v[140:143], v[48:63]
    ds_read_b128 v[132:135], v154 offset:18432
    ds_read_b64_tr_b16 v[180:181], v152 offset:55296
    s_waitcnt lgkmcnt(9)
    v_mfma_f32_32x32x16_bf16 v[64:79], v[200:203], v[144:147], v[64:79]
    ds_read_b128 v[136:139], v154 offset:22528
    ds_read_b64_tr_b16 v[182:183], v152 offset:56064
    v_mfma_f32_16x16x32_bf16 v[112:115], v[160:163], v[120:123], v[112:115]
    v_mfma_f32_16x16x32_bf16 v[116:119], v[164:167], v[120:123], v[116:119]
    s_waitcnt lgkmcnt(9)
    v_mfma_f32_32x32x16_bf16 v[16:31], v[208:211], v[124:127], v[16:31]
    ds_read_b128 v[140:143], v153 offset:19456
    ds_read_b64_tr_b16 v[184:185], v149 offset:56832
    v_mfma_f32_32x32x16_bf16 v[80:95], v[212:215], v[124:127], v[80:95]
    ds_read_b64_tr_b16 v[186:187], v149 offset:57600
    s_waitcnt lgkmcnt(9)
    v_mfma_f32_32x32x16_bf16 v[32:47], v[208:211], v[128:131], v[32:47]
    ds_read_b128 v[144:147], v153 offset:23552
    ds_read_b64_tr_b16 v[188:189], v152 offset:56832
    v_mfma_f32_32x32x16_bf16 v[96:111], v[212:215], v[128:131], v[96:111]
    ds_read_b64_tr_b16 v[190:191], v152 offset:57600
    s_waitcnt lgkmcnt(9)
    v_mfma_f32_32x32x16_bf16 v[48:63], v[208:211], v[132:135], v[48:63]
    ds_read_b128 v[124:127], v154 offset:19456
    s_waitcnt lgkmcnt(8)
    v_mfma_f32_32x32x16_bf16 v[64:79], v[208:211], v[136:139], v[64:79]
    ds_read_b128 v[128:131], v154 offset:23552
    v_mfma_f32_16x16x32_bf16 v[112:115], v[168:171], v[120:123], v[112:115]
    v_mfma_f32_16x16x32_bf16 v[116:119], v[172:175], v[120:123], v[116:119]
    v_mfma_f32_16x16x32_bf16 v[112:115], v[176:179], v[120:123], v[112:115]
    s_waitcnt lgkmcnt(8)
    v_mfma_f32_16x16x32_bf16 v[116:119], v[180:183], v[120:123], v[116:119]
    s_waitcnt lgkmcnt(0)
    s_barrier
    v_mfma_f32_32x32x16_bf16 v[16:31], v[216:219], v[140:143], v[16:31]
    ds_read_b128 v[132:135], v153 offset:32768
    v_mfma_f32_32x32x16_bf16 v[80:95], v[220:223], v[140:143], v[80:95]
    v_mfma_f32_32x32x16_bf16 v[32:47], v[216:219], v[144:147], v[32:47]
    ds_read_b128 v[136:139], v153 offset:36864
    v_mfma_f32_32x32x16_bf16 v[96:111], v[220:223], v[144:147], v[96:111]
    v_mfma_f32_32x32x16_bf16 v[48:63], v[216:219], v[124:127], v[48:63]
    ds_read_b128 v[140:143], v154 offset:32768
    v_mfma_f32_32x32x16_bf16 v[64:79], v[216:219], v[128:131], v[64:79]
    ds_read_b128 v[144:147], v154 offset:36864
    v_mfma_f32_16x16x32_bf16 v[112:115], v[184:187], v[120:123], v[112:115]
    v_mfma_f32_16x16x32_bf16 v[116:119], v[188:191], v[120:123], v[116:119]
    s_waitcnt lgkmcnt(3)
    v_mfma_f32_32x32x16_bf16 v[16:31], v[224:227], v[132:135], v[16:31]
    ds_read_b128 v[124:127], v153 offset:33792
    ds_read_b64_tr_b16 v[192:193], v149 offset:0
    v_mfma_f32_32x32x16_bf16 v[80:95], v[228:231], v[132:135], v[80:95]
    ds_read_b64_tr_b16 v[194:195], v149 offset:768
    s_waitcnt lgkmcnt(5)
    v_mfma_f32_32x32x16_bf16 v[32:47], v[224:227], v[136:139], v[32:47]
    ds_read_b128 v[128:131], v153 offset:37888
    ds_read_b64_tr_b16 v[196:197], v152 offset:0
    v_mfma_f32_32x32x16_bf16 v[96:111], v[228:231], v[136:139], v[96:111]
    ds_read_b64_tr_b16 v[198:199], v152 offset:768
    s_waitcnt lgkmcnt(7)
    v_mfma_f32_32x32x16_bf16 v[48:63], v[224:227], v[140:143], v[48:63]
    ds_read_b128 v[132:135], v154 offset:33792
    ds_read_b64_tr_b16 v[200:201], v149 offset:1536
    s_waitcnt lgkmcnt(8)
    v_mfma_f32_32x32x16_bf16 v[64:79], v[224:227], v[144:147], v[64:79]
    ds_read_b128 v[136:139], v154 offset:37888
    ds_read_b64_tr_b16 v[202:203], v149 offset:2304
    s_waitcnt lgkmcnt(9)
    v_mfma_f32_32x32x16_bf16 v[16:31], v[232:235], v[124:127], v[16:31]
    ds_read_b128 v[140:143], v153 offset:34816
    ds_read_b64_tr_b16 v[204:205], v152 offset:1536
    v_mfma_f32_32x32x16_bf16 v[80:95], v[236:239], v[124:127], v[80:95]
    ds_read_b64_tr_b16 v[206:207], v152 offset:2304
    s_waitcnt lgkmcnt(9)
    v_mfma_f32_32x32x16_bf16 v[32:47], v[232:235], v[128:131], v[32:47]
    ds_read_b128 v[144:147], v153 offset:38912
    ds_read_b64_tr_b16 v[208:209], v149 offset:6144
    v_mfma_f32_32x32x16_bf16 v[96:111], v[236:239], v[128:131], v[96:111]
    ds_read_b64_tr_b16 v[210:211], v149 offset:6912
    s_waitcnt lgkmcnt(9)
    v_mfma_f32_32x32x16_bf16 v[48:63], v[232:235], v[132:135], v[48:63]
    ds_read_b128 v[124:127], v154 offset:34816
    ds_read_b64_tr_b16 v[212:213], v152 offset:6144
    s_waitcnt lgkmcnt(9)
    v_mfma_f32_32x32x16_bf16 v[64:79], v[232:235], v[136:139], v[64:79]
    ds_read_b128 v[128:131], v154 offset:38912
    ds_read_b64_tr_b16 v[214:215], v152 offset:6912
    v_mfma_f32_16x16x32_bf16 v[112:115], v[192:195], v[120:123], v[112:115]
    v_mfma_f32_16x16x32_bf16 v[116:119], v[196:199], v[120:123], v[116:119]
    s_waitcnt lgkmcnt(9)
    v_mfma_f32_32x32x16_bf16 v[16:31], v[240:243], v[140:143], v[16:31]
    ds_read_b128 v[132:135], v153 offset:35840
    ds_read_b64_tr_b16 v[216:217], v149 offset:7680
    v_mfma_f32_32x32x16_bf16 v[80:95], v[244:247], v[140:143], v[80:95]
    ds_read_b64_tr_b16 v[218:219], v149 offset:8448
    s_waitcnt lgkmcnt(9)
    v_mfma_f32_32x32x16_bf16 v[32:47], v[240:243], v[144:147], v[32:47]
    ds_read_b128 v[136:139], v153 offset:39936
    ds_read_b64_tr_b16 v[220:221], v152 offset:7680
    v_mfma_f32_32x32x16_bf16 v[96:111], v[244:247], v[144:147], v[96:111]
    ds_read_b64_tr_b16 v[222:223], v152 offset:8448
    s_waitcnt lgkmcnt(9)
    v_mfma_f32_32x32x16_bf16 v[48:63], v[240:243], v[124:127], v[48:63]
    ds_read_b128 v[140:143], v154 offset:35840
    s_waitcnt lgkmcnt(8)
    v_mfma_f32_32x32x16_bf16 v[64:79], v[240:243], v[128:131], v[64:79]
    ds_read_b128 v[144:147], v154 offset:39936
    v_mfma_f32_16x16x32_bf16 v[112:115], v[200:203], v[120:123], v[112:115]
    v_mfma_f32_16x16x32_bf16 v[116:119], v[204:207], v[120:123], v[116:119]
    v_mfma_f32_16x16x32_bf16 v[112:115], v[208:211], v[120:123], v[112:115]
    s_waitcnt lgkmcnt(8)
    v_mfma_f32_16x16x32_bf16 v[116:119], v[212:215], v[120:123], v[116:119]
    s_waitcnt lgkmcnt(0)
    s_barrier
    v_mfma_f32_32x32x16_bf16 v[16:31], v[248:251], v[132:135], v[16:31]
    ds_read_b128 v[124:127], v153 offset:0
    v_mfma_f32_32x32x16_bf16 v[80:95], v[252:255], v[132:135], v[80:95]
    v_mfma_f32_32x32x16_bf16 v[32:47], v[248:251], v[136:139], v[32:47]
    ds_read_b128 v[128:131], v153 offset:4096
    v_mfma_f32_32x32x16_bf16 v[96:111], v[252:255], v[136:139], v[96:111]
    v_mfma_f32_32x32x16_bf16 v[48:63], v[248:251], v[140:143], v[48:63]
    ds_read_b128 v[132:135], v154 offset:0
    v_mfma_f32_32x32x16_bf16 v[64:79], v[248:251], v[144:147], v[64:79]
    ds_read_b128 v[136:139], v154 offset:4096
    v_mfma_f32_16x16x32_bf16 v[112:115], v[216:219], v[120:123], v[112:115]
    v_mfma_f32_16x16x32_bf16 v[116:119], v[220:223], v[120:123], v[116:119]
    s_waitcnt lgkmcnt(3)
    v_mfma_f32_32x32x16_bf16 v[16:31], v[160:163], v[124:127], v[16:31]
    ds_read_b128 v[140:143], v153 offset:1024
    ds_read_b64_tr_b16 v[224:225], v149 offset:24576
    v_mfma_f32_32x32x16_bf16 v[80:95], v[164:167], v[124:127], v[80:95]
    ds_read_b64_tr_b16 v[226:227], v149 offset:25344
    s_waitcnt lgkmcnt(5)
    v_mfma_f32_32x32x16_bf16 v[32:47], v[160:163], v[128:131], v[32:47]
    ds_read_b128 v[144:147], v153 offset:5120
    ds_read_b64_tr_b16 v[228:229], v152 offset:24576
    v_mfma_f32_32x32x16_bf16 v[96:111], v[164:167], v[128:131], v[96:111]
    ds_read_b64_tr_b16 v[230:231], v152 offset:25344
    s_waitcnt lgkmcnt(7)
    v_mfma_f32_32x32x16_bf16 v[48:63], v[160:163], v[132:135], v[48:63]
    ds_read_b128 v[124:127], v154 offset:1024
    ds_read_b64_tr_b16 v[232:233], v149 offset:26112
    s_waitcnt lgkmcnt(8)
    v_mfma_f32_32x32x16_bf16 v[64:79], v[160:163], v[136:139], v[64:79]
    ds_read_b128 v[128:131], v154 offset:5120
    ds_read_b64_tr_b16 v[234:235], v149 offset:26880
    s_waitcnt lgkmcnt(9)
    v_mfma_f32_32x32x16_bf16 v[16:31], v[168:171], v[140:143], v[16:31]
    ds_read_b128 v[132:135], v153 offset:2048
    ds_read_b64_tr_b16 v[236:237], v152 offset:26112
    v_mfma_f32_32x32x16_bf16 v[80:95], v[172:175], v[140:143], v[80:95]
    ds_read_b64_tr_b16 v[238:239], v152 offset:26880
    s_waitcnt lgkmcnt(9)
    v_mfma_f32_32x32x16_bf16 v[32:47], v[168:171], v[144:147], v[32:47]
    ds_read_b128 v[136:139], v153 offset:6144
    ds_read_b64_tr_b16 v[240:241], v149 offset:30720
    v_mfma_f32_32x32x16_bf16 v[96:111], v[172:175], v[144:147], v[96:111]
    ds_read_b64_tr_b16 v[242:243], v149 offset:31488
    s_waitcnt lgkmcnt(9)
    v_mfma_f32_32x32x16_bf16 v[48:63], v[168:171], v[124:127], v[48:63]
    ds_read_b128 v[140:143], v154 offset:2048
    ds_read_b64_tr_b16 v[244:245], v152 offset:30720
    s_waitcnt lgkmcnt(9)
    v_mfma_f32_32x32x16_bf16 v[64:79], v[168:171], v[128:131], v[64:79]
    ds_read_b128 v[144:147], v154 offset:6144
    ds_read_b64_tr_b16 v[246:247], v152 offset:31488
    v_mfma_f32_16x16x32_bf16 v[112:115], v[224:227], v[120:123], v[112:115]
    v_mfma_f32_16x16x32_bf16 v[116:119], v[228:231], v[120:123], v[116:119]
    s_waitcnt lgkmcnt(9)
    v_mfma_f32_32x32x16_bf16 v[16:31], v[176:179], v[132:135], v[16:31]
    ds_read_b128 v[124:127], v153 offset:3072
    ds_read_b64_tr_b16 v[248:249], v149 offset:32256
    v_mfma_f32_32x32x16_bf16 v[80:95], v[180:183], v[132:135], v[80:95]
    ds_read_b64_tr_b16 v[250:251], v149 offset:33024
    s_waitcnt lgkmcnt(9)
    v_mfma_f32_32x32x16_bf16 v[32:47], v[176:179], v[136:139], v[32:47]
    ds_read_b128 v[128:131], v153 offset:7168
    ds_read_b64_tr_b16 v[252:253], v152 offset:32256
    v_mfma_f32_32x32x16_bf16 v[96:111], v[180:183], v[136:139], v[96:111]
    ds_read_b64_tr_b16 v[254:255], v152 offset:33024
    s_waitcnt lgkmcnt(9)
    v_mfma_f32_32x32x16_bf16 v[48:63], v[176:179], v[140:143], v[48:63]
    ds_read_b128 v[132:135], v154 offset:3072
    s_waitcnt lgkmcnt(8)
    v_mfma_f32_32x32x16_bf16 v[64:79], v[176:179], v[144:147], v[64:79]
    ds_read_b128 v[136:139], v154 offset:7168
    v_mfma_f32_16x16x32_bf16 v[112:115], v[232:235], v[120:123], v[112:115]
    v_mfma_f32_16x16x32_bf16 v[116:119], v[236:239], v[120:123], v[116:119]
    v_mfma_f32_16x16x32_bf16 v[112:115], v[240:243], v[120:123], v[112:115]
    s_waitcnt lgkmcnt(8)
    v_mfma_f32_16x16x32_bf16 v[116:119], v[244:247], v[120:123], v[116:119]
    s_waitcnt lgkmcnt(0)
    s_barrier
    v_mfma_f32_32x32x16_bf16 v[16:31], v[184:187], v[124:127], v[16:31]
    ds_read_b128 v[140:143], v153 offset:16384
    v_mfma_f32_32x32x16_bf16 v[80:95], v[188:191], v[124:127], v[80:95]
    v_mfma_f32_32x32x16_bf16 v[32:47], v[184:187], v[128:131], v[32:47]
    ds_read_b128 v[144:147], v153 offset:20480
    v_mfma_f32_32x32x16_bf16 v[96:111], v[188:191], v[128:131], v[96:111]
    v_mfma_f32_32x32x16_bf16 v[48:63], v[184:187], v[132:135], v[48:63]
    ds_read_b128 v[124:127], v154 offset:16384
    v_mfma_f32_32x32x16_bf16 v[64:79], v[184:187], v[136:139], v[64:79]
    ds_read_b128 v[128:131], v154 offset:20480
    v_mfma_f32_16x16x32_bf16 v[112:115], v[248:251], v[120:123], v[112:115]
    v_mfma_f32_16x16x32_bf16 v[116:119], v[252:255], v[120:123], v[116:119]
    s_waitcnt lgkmcnt(3)
    v_mfma_f32_32x32x16_bf16 v[16:31], v[192:195], v[140:143], v[16:31]
    ds_read_b128 v[132:135], v153 offset:17408
    ds_read_b64_tr_b16 v[160:161], v149 offset:49152
    v_mfma_f32_32x32x16_bf16 v[80:95], v[196:199], v[140:143], v[80:95]
    ds_read_b64_tr_b16 v[162:163], v149 offset:49920
    s_waitcnt lgkmcnt(5)
    v_mfma_f32_32x32x16_bf16 v[32:47], v[192:195], v[144:147], v[32:47]
    ds_read_b128 v[136:139], v153 offset:21504
    ds_read_b64_tr_b16 v[164:165], v152 offset:49152
    v_mfma_f32_32x32x16_bf16 v[96:111], v[196:199], v[144:147], v[96:111]
    ds_read_b64_tr_b16 v[166:167], v152 offset:49920
    s_waitcnt lgkmcnt(7)
    v_mfma_f32_32x32x16_bf16 v[48:63], v[192:195], v[124:127], v[48:63]
    ds_read_b128 v[140:143], v154 offset:17408
    ds_read_b64_tr_b16 v[168:169], v149 offset:50688
    s_waitcnt lgkmcnt(8)
    v_mfma_f32_32x32x16_bf16 v[64:79], v[192:195], v[128:131], v[64:79]
    ds_read_b128 v[144:147], v154 offset:21504
    ds_read_b64_tr_b16 v[170:171], v149 offset:51456
    s_waitcnt lgkmcnt(9)
    v_mfma_f32_32x32x16_bf16 v[16:31], v[200:203], v[132:135], v[16:31]
    ds_read_b128 v[124:127], v153 offset:18432
    ds_read_b64_tr_b16 v[172:173], v152 offset:50688
    v_mfma_f32_32x32x16_bf16 v[80:95], v[204:207], v[132:135], v[80:95]
    ds_read_b64_tr_b16 v[174:175], v152 offset:51456
    s_waitcnt lgkmcnt(9)
    v_mfma_f32_32x32x16_bf16 v[32:47], v[200:203], v[136:139], v[32:47]
    ds_read_b128 v[128:131], v153 offset:22528
    ds_read_b64_tr_b16 v[176:177], v149 offset:55296
    v_mfma_f32_32x32x16_bf16 v[96:111], v[204:207], v[136:139], v[96:111]
    ds_read_b64_tr_b16 v[178:179], v149 offset:56064
    s_waitcnt lgkmcnt(9)
    v_mfma_f32_32x32x16_bf16 v[48:63], v[200:203], v[140:143], v[48:63]
    ds_read_b128 v[132:135], v154 offset:18432
    ds_read_b64_tr_b16 v[180:181], v152 offset:55296
    s_waitcnt lgkmcnt(9)
    v_mfma_f32_32x32x16_bf16 v[64:79], v[200:203], v[144:147], v[64:79]
    ds_read_b128 v[136:139], v154 offset:22528
    ds_read_b64_tr_b16 v[182:183], v152 offset:56064
    v_mfma_f32_16x16x32_bf16 v[112:115], v[160:163], v[120:123], v[112:115]
    v_mfma_f32_16x16x32_bf16 v[116:119], v[164:167], v[120:123], v[116:119]
    s_waitcnt lgkmcnt(9)
    v_mfma_f32_32x32x16_bf16 v[16:31], v[208:211], v[124:127], v[16:31]
    ds_read_b128 v[140:143], v153 offset:19456
    ds_read_b64_tr_b16 v[184:185], v149 offset:56832
    v_mfma_f32_32x32x16_bf16 v[80:95], v[212:215], v[124:127], v[80:95]
    ds_read_b64_tr_b16 v[186:187], v149 offset:57600
    s_waitcnt lgkmcnt(9)
    v_mfma_f32_32x32x16_bf16 v[32:47], v[208:211], v[128:131], v[32:47]
    ds_read_b128 v[144:147], v153 offset:23552
    ds_read_b64_tr_b16 v[188:189], v152 offset:56832
    v_mfma_f32_32x32x16_bf16 v[96:111], v[212:215], v[128:131], v[96:111]
    ds_read_b64_tr_b16 v[190:191], v152 offset:57600
    s_waitcnt lgkmcnt(9)
    v_mfma_f32_32x32x16_bf16 v[48:63], v[208:211], v[132:135], v[48:63]
    ds_read_b128 v[124:127], v154 offset:19456
    s_waitcnt lgkmcnt(8)
    v_mfma_f32_32x32x16_bf16 v[64:79], v[208:211], v[136:139], v[64:79]
    ds_read_b128 v[128:131], v154 offset:23552
    v_mfma_f32_16x16x32_bf16 v[112:115], v[168:171], v[120:123], v[112:115]
    v_mfma_f32_16x16x32_bf16 v[116:119], v[172:175], v[120:123], v[116:119]
    v_mfma_f32_16x16x32_bf16 v[112:115], v[176:179], v[120:123], v[112:115]
    s_waitcnt lgkmcnt(8)
    v_mfma_f32_16x16x32_bf16 v[116:119], v[180:183], v[120:123], v[116:119]
    s_waitcnt lgkmcnt(0)
    s_barrier
    v_mfma_f32_32x32x16_bf16 v[16:31], v[216:219], v[140:143], v[16:31]
    ds_read_b128 v[132:135], v153 offset:32768
    v_mfma_f32_32x32x16_bf16 v[80:95], v[220:223], v[140:143], v[80:95]
    v_mfma_f32_32x32x16_bf16 v[32:47], v[216:219], v[144:147], v[32:47]
    ds_read_b128 v[136:139], v153 offset:36864
    v_mfma_f32_32x32x16_bf16 v[96:111], v[220:223], v[144:147], v[96:111]
    v_mfma_f32_32x32x16_bf16 v[48:63], v[216:219], v[124:127], v[48:63]
    ds_read_b128 v[140:143], v154 offset:32768
    v_mfma_f32_32x32x16_bf16 v[64:79], v[216:219], v[128:131], v[64:79]
    ds_read_b128 v[144:147], v154 offset:36864
    v_mfma_f32_16x16x32_bf16 v[112:115], v[184:187], v[120:123], v[112:115]
    v_mfma_f32_16x16x32_bf16 v[116:119], v[188:191], v[120:123], v[116:119]
    s_waitcnt lgkmcnt(3)
    v_mfma_f32_32x32x16_bf16 v[16:31], v[224:227], v[132:135], v[16:31]
    ds_read_b128 v[124:127], v153 offset:33792
    ds_read_b64_tr_b16 v[192:193], v149 offset:0
    v_mfma_f32_32x32x16_bf16 v[80:95], v[228:231], v[132:135], v[80:95]
    ds_read_b64_tr_b16 v[194:195], v149 offset:768
    s_waitcnt lgkmcnt(5)
    v_mfma_f32_32x32x16_bf16 v[32:47], v[224:227], v[136:139], v[32:47]
    ds_read_b128 v[128:131], v153 offset:37888
    ds_read_b64_tr_b16 v[196:197], v152 offset:0
    v_mfma_f32_32x32x16_bf16 v[96:111], v[228:231], v[136:139], v[96:111]
    ds_read_b64_tr_b16 v[198:199], v152 offset:768
    s_waitcnt lgkmcnt(7)
    v_mfma_f32_32x32x16_bf16 v[48:63], v[224:227], v[140:143], v[48:63]
    ds_read_b128 v[132:135], v154 offset:33792
    ds_read_b64_tr_b16 v[200:201], v149 offset:1536
    s_waitcnt lgkmcnt(8)
    v_mfma_f32_32x32x16_bf16 v[64:79], v[224:227], v[144:147], v[64:79]
    ds_read_b128 v[136:139], v154 offset:37888
    ds_read_b64_tr_b16 v[202:203], v149 offset:2304
    s_waitcnt lgkmcnt(9)
    v_mfma_f32_32x32x16_bf16 v[16:31], v[232:235], v[124:127], v[16:31]
    ds_read_b128 v[140:143], v153 offset:34816
    ds_read_b64_tr_b16 v[204:205], v152 offset:1536
    v_mfma_f32_32x32x16_bf16 v[80:95], v[236:239], v[124:127], v[80:95]
    ds_read_b64_tr_b16 v[206:207], v152 offset:2304
    s_waitcnt lgkmcnt(9)
    v_mfma_f32_32x32x16_bf16 v[32:47], v[232:235], v[128:131], v[32:47]
    ds_read_b128 v[144:147], v153 offset:38912
    ds_read_b64_tr_b16 v[208:209], v149 offset:6144
    v_mfma_f32_32x32x16_bf16 v[96:111], v[236:239], v[128:131], v[96:111]
    ds_read_b64_tr_b16 v[210:211], v149 offset:6912
    s_waitcnt lgkmcnt(9)
    v_mfma_f32_32x32x16_bf16 v[48:63], v[232:235], v[132:135], v[48:63]
    ds_read_b128 v[124:127], v154 offset:34816
    ds_read_b64_tr_b16 v[212:213], v152 offset:6144
    s_waitcnt lgkmcnt(9)
    v_mfma_f32_32x32x16_bf16 v[64:79], v[232:235], v[136:139], v[64:79]
    ds_read_b128 v[128:131], v154 offset:38912
    ds_read_b64_tr_b16 v[214:215], v152 offset:6912
    v_mfma_f32_16x16x32_bf16 v[112:115], v[192:195], v[120:123], v[112:115]
    v_mfma_f32_16x16x32_bf16 v[116:119], v[196:199], v[120:123], v[116:119]
    s_waitcnt lgkmcnt(9)
    v_mfma_f32_32x32x16_bf16 v[16:31], v[240:243], v[140:143], v[16:31]
    ds_read_b128 v[132:135], v153 offset:35840
    ds_read_b64_tr_b16 v[216:217], v149 offset:7680
    v_mfma_f32_32x32x16_bf16 v[80:95], v[244:247], v[140:143], v[80:95]
    ds_read_b64_tr_b16 v[218:219], v149 offset:8448
    s_waitcnt lgkmcnt(9)
    v_mfma_f32_32x32x16_bf16 v[32:47], v[240:243], v[144:147], v[32:47]
    ds_read_b128 v[136:139], v153 offset:39936
    ds_read_b64_tr_b16 v[220:221], v152 offset:7680
    v_mfma_f32_32x32x16_bf16 v[96:111], v[244:247], v[144:147], v[96:111]
    ds_read_b64_tr_b16 v[222:223], v152 offset:8448
    s_waitcnt lgkmcnt(9)
    v_mfma_f32_32x32x16_bf16 v[48:63], v[240:243], v[124:127], v[48:63]
    ds_read_b128 v[140:143], v154 offset:35840
    s_waitcnt lgkmcnt(8)
    v_mfma_f32_32x32x16_bf16 v[64:79], v[240:243], v[128:131], v[64:79]
    ds_read_b128 v[144:147], v154 offset:39936
    v_mfma_f32_16x16x32_bf16 v[112:115], v[200:203], v[120:123], v[112:115]
    v_mfma_f32_16x16x32_bf16 v[116:119], v[204:207], v[120:123], v[116:119]
    v_mfma_f32_16x16x32_bf16 v[112:115], v[208:211], v[120:123], v[112:115]
    s_waitcnt lgkmcnt(8)
    v_mfma_f32_16x16x32_bf16 v[116:119], v[212:215], v[120:123], v[116:119]
    s_waitcnt lgkmcnt(0)
    s_barrier
    v_mfma_f32_32x32x16_bf16 v[16:31], v[248:251], v[132:135], v[16:31]
    ds_read_b128 v[124:127], v153 offset:0
    v_mfma_f32_32x32x16_bf16 v[80:95], v[252:255], v[132:135], v[80:95]
    v_mfma_f32_32x32x16_bf16 v[32:47], v[248:251], v[136:139], v[32:47]
    ds_read_b128 v[128:131], v153 offset:4096
    v_mfma_f32_32x32x16_bf16 v[96:111], v[252:255], v[136:139], v[96:111]
    v_mfma_f32_32x32x16_bf16 v[48:63], v[248:251], v[140:143], v[48:63]
    ds_read_b128 v[132:135], v154 offset:0
    v_mfma_f32_32x32x16_bf16 v[64:79], v[248:251], v[144:147], v[64:79]
    ds_read_b128 v[136:139], v154 offset:4096
    v_mfma_f32_16x16x32_bf16 v[112:115], v[216:219], v[120:123], v[112:115]
    v_mfma_f32_16x16x32_bf16 v[116:119], v[220:223], v[120:123], v[116:119]
    s_waitcnt lgkmcnt(3)
    v_mfma_f32_32x32x16_bf16 v[16:31], v[160:163], v[124:127], v[16:31]
    ds_read_b128 v[140:143], v153 offset:1024
    v_mfma_f32_32x32x16_bf16 v[80:95], v[164:167], v[124:127], v[80:95]
    s_waitcnt lgkmcnt(3)
    v_mfma_f32_32x32x16_bf16 v[32:47], v[160:163], v[128:131], v[32:47]
    ds_read_b128 v[144:147], v153 offset:5120
    v_mfma_f32_32x32x16_bf16 v[96:111], v[164:167], v[128:131], v[96:111]
    s_waitcnt lgkmcnt(3)
    v_mfma_f32_32x32x16_bf16 v[48:63], v[160:163], v[132:135], v[48:63]
    ds_read_b128 v[124:127], v154 offset:1024
    s_waitcnt lgkmcnt(3)
    v_mfma_f32_32x32x16_bf16 v[64:79], v[160:163], v[136:139], v[64:79]
    ds_read_b128 v[128:131], v154 offset:5120
    s_waitcnt lgkmcnt(3)
    v_mfma_f32_32x32x16_bf16 v[16:31], v[168:171], v[140:143], v[16:31]
    ds_read_b128 v[132:135], v153 offset:2048
    v_mfma_f32_32x32x16_bf16 v[80:95], v[172:175], v[140:143], v[80:95]
    s_waitcnt lgkmcnt(3)
    v_mfma_f32_32x32x16_bf16 v[32:47], v[168:171], v[144:147], v[32:47]
    ds_read_b128 v[136:139], v153 offset:6144
    v_mfma_f32_32x32x16_bf16 v[96:111], v[172:175], v[144:147], v[96:111]
    s_waitcnt lgkmcnt(3)
    v_mfma_f32_32x32x16_bf16 v[48:63], v[168:171], v[124:127], v[48:63]
    ds_read_b128 v[140:143], v154 offset:2048
    s_waitcnt lgkmcnt(3)
    v_mfma_f32_32x32x16_bf16 v[64:79], v[168:171], v[128:131], v[64:79]
    ds_read_b128 v[144:147], v154 offset:6144
    s_waitcnt lgkmcnt(3)
    v_mfma_f32_32x32x16_bf16 v[16:31], v[176:179], v[132:135], v[16:31]
    ds_read_b128 v[124:127], v153 offset:3072
    v_mfma_f32_32x32x16_bf16 v[80:95], v[180:183], v[132:135], v[80:95]
    s_waitcnt lgkmcnt(3)
    v_mfma_f32_32x32x16_bf16 v[32:47], v[176:179], v[136:139], v[32:47]
    ds_read_b128 v[128:131], v153 offset:7168
    v_mfma_f32_32x32x16_bf16 v[96:111], v[180:183], v[136:139], v[96:111]
    s_waitcnt lgkmcnt(3)
    v_mfma_f32_32x32x16_bf16 v[48:63], v[176:179], v[140:143], v[48:63]
    ds_read_b128 v[132:135], v154 offset:3072
    s_waitcnt lgkmcnt(3)
    v_mfma_f32_32x32x16_bf16 v[64:79], v[176:179], v[144:147], v[64:79]
    ds_read_b128 v[136:139], v154 offset:7168
    s_waitcnt lgkmcnt(0)
    s_barrier
    v_mfma_f32_32x32x16_bf16 v[16:31], v[184:187], v[124:127], v[16:31]
    ds_read_b128 v[140:143], v153 offset:16384
    v_mfma_f32_32x32x16_bf16 v[80:95], v[188:191], v[124:127], v[80:95]
    v_mfma_f32_32x32x16_bf16 v[32:47], v[184:187], v[128:131], v[32:47]
    ds_read_b128 v[144:147], v153 offset:20480
    v_mfma_f32_32x32x16_bf16 v[96:111], v[188:191], v[128:131], v[96:111]
    v_mfma_f32_32x32x16_bf16 v[48:63], v[184:187], v[132:135], v[48:63]
    ds_read_b128 v[124:127], v154 offset:16384
    v_mfma_f32_32x32x16_bf16 v[64:79], v[184:187], v[136:139], v[64:79]
    ds_read_b128 v[128:131], v154 offset:20480
    s_waitcnt lgkmcnt(3)
    v_mfma_f32_32x32x16_bf16 v[16:31], v[192:195], v[140:143], v[16:31]
    ds_read_b128 v[132:135], v153 offset:17408
    v_mfma_f32_32x32x16_bf16 v[80:95], v[196:199], v[140:143], v[80:95]
    s_waitcnt lgkmcnt(3)
    v_mfma_f32_32x32x16_bf16 v[32:47], v[192:195], v[144:147], v[32:47]
    ds_read_b128 v[136:139], v153 offset:21504
    v_mfma_f32_32x32x16_bf16 v[96:111], v[196:199], v[144:147], v[96:111]
    s_waitcnt lgkmcnt(3)
    v_mfma_f32_32x32x16_bf16 v[48:63], v[192:195], v[124:127], v[48:63]
    ds_read_b128 v[140:143], v154 offset:17408
    s_waitcnt lgkmcnt(3)
    v_mfma_f32_32x32x16_bf16 v[64:79], v[192:195], v[128:131], v[64:79]
    ds_read_b128 v[144:147], v154 offset:21504
    s_waitcnt lgkmcnt(3)
    v_mfma_f32_32x32x16_bf16 v[16:31], v[200:203], v[132:135], v[16:31]
    ds_read_b128 v[124:127], v153 offset:18432
    v_mfma_f32_32x32x16_bf16 v[80:95], v[204:207], v[132:135], v[80:95]
    s_waitcnt lgkmcnt(3)
    v_mfma_f32_32x32x16_bf16 v[32:47], v[200:203], v[136:139], v[32:47]
    ds_read_b128 v[128:131], v153 offset:22528
    v_mfma_f32_32x32x16_bf16 v[96:111], v[204:207], v[136:139], v[96:111]
    s_waitcnt lgkmcnt(3)
    v_mfma_f32_32x32x16_bf16 v[48:63], v[200:203], v[140:143], v[48:63]
    ds_read_b128 v[132:135], v154 offset:18432
    s_waitcnt lgkmcnt(3)
    v_mfma_f32_32x32x16_bf16 v[64:79], v[200:203], v[144:147], v[64:79]
    ds_read_b128 v[136:139], v154 offset:22528
    s_waitcnt lgkmcnt(3)
    v_mfma_f32_32x32x16_bf16 v[16:31], v[208:211], v[124:127], v[16:31]
    ds_read_b128 v[140:143], v153 offset:19456
    v_mfma_f32_32x32x16_bf16 v[80:95], v[212:215], v[124:127], v[80:95]
    s_waitcnt lgkmcnt(3)
    v_mfma_f32_32x32x16_bf16 v[32:47], v[208:211], v[128:131], v[32:47]
    ds_read_b128 v[144:147], v153 offset:23552
    v_mfma_f32_32x32x16_bf16 v[96:111], v[212:215], v[128:131], v[96:111]
    s_waitcnt lgkmcnt(3)
    v_mfma_f32_32x32x16_bf16 v[48:63], v[208:211], v[132:135], v[48:63]
    ds_read_b128 v[124:127], v154 offset:19456
    s_waitcnt lgkmcnt(3)
    v_mfma_f32_32x32x16_bf16 v[64:79], v[208:211], v[136:139], v[64:79]
    ds_read_b128 v[128:131], v154 offset:23552
    s_waitcnt lgkmcnt(3)
    v_mfma_f32_32x32x16_bf16 v[16:31], v[216:219], v[140:143], v[16:31]
    v_mfma_f32_32x32x16_bf16 v[80:95], v[220:223], v[140:143], v[80:95]
    s_waitcnt lgkmcnt(2)
    v_mfma_f32_32x32x16_bf16 v[32:47], v[216:219], v[144:147], v[32:47]
    v_mfma_f32_32x32x16_bf16 v[96:111], v[220:223], v[144:147], v[96:111]
    s_waitcnt lgkmcnt(1)
    v_mfma_f32_32x32x16_bf16 v[48:63], v[216:219], v[124:127], v[48:63]
    s_waitcnt lgkmcnt(0)
    v_mfma_f32_32x32x16_bf16 v[64:79], v[216:219], v[128:131], v[64:79]
    v_and_b32 v2, 1, v0
    v_lshrrev_b32 v3, 4, v0
    v_lshlrev_b32 v2, 6, v2
    v_lshl_add_u32 v2, v3, 4, v2
    s_lshl_b32 s55, s44, 8
    s_add_u32 s55, s55, 157696
    v_add_u32 v2, s55, v2
    v_lshrrev_b32 v3, 5, v0
    v_lshlrev_b32 v3, 4, v3
    v_add_u32 v3, s55, v3
    ds_write_b128 v2, v[112:115]
    ds_write_b128 v2, v[116:119] offset:128
    s_and_b32 s50, s44, 1
    s_lshl_b32 s50, s50, 9
    s_add_u32 s50, s50, 156672
    v_and_b32 v13, 31, v0
    v_lshlrev_b32 v13, 3, v13
    v_add_u32 v13, s50, v13
    v_xor_b32 v14, 0x200, v13
    ds_read_b64 v[160:161], v13
    ds_read_b64 v[162:163], v13 offset:256
    ds_read_b64 v[164:165], v14
    ds_read_b64 v[166:167], v14 offset:256
    ds_read_b128 v[176:179], v3 offset:0
    ds_read_b128 v[180:183], v3 offset:32
    ds_read_b128 v[184:187], v3 offset:64
    ds_read_b128 v[188:191], v3 offset:96
    ds_read_b128 v[192:195], v3 offset:128
    ds_read_b128 v[196:199], v3 offset:160
    ds_read_b128 v[200:203], v3 offset:192
    ds_read_b128 v[204:207], v3 offset:224
    s_mul_i32 s50, s47, 6144
    s_add_u32 s50, s50, 266240
    s_and_b32 s51, s44, 1
    s_mul_i32 s51, s51, 180224
    s_add_u32 s52, s50, s51
    s_sub_u32 s53, s50, s51
    s_add_u32 s53, s53, 180224
    s_lshl_b32 s50, s44, 10
    v_add_u32 v8, s50, v148
    v_add_u32 v9, 90112, v8
    s_lshr_b32 s50, s44, 1
    s_lshl_b32 s50, s50, 10
    s_add_u32 s50, s50, 4096
    v_add_u32 v10, s50, v148
    v_add_u32 v11, 90112, v10
    s_waitcnt lgkmcnt(7)
    v_pk_fma_f32 v[16:17], v[176:177], v[160:161], v[16:17] op_sel:[0,0,0] op_sel_hi:[1,0,1]
    v_pk_fma_f32 v[18:19], v[178:179], v[160:161], v[18:19] op_sel:[0,0,0] op_sel_hi:[1,0,1]
    s_waitcnt lgkmcnt(6)
    v_pk_fma_f32 v[20:21], v[180:181], v[160:161], v[20:21] op_sel:[0,0,0] op_sel_hi:[1,0,1]
    v_pk_fma_f32 v[22:23], v[182:183], v[160:161], v[22:23] op_sel:[0,0,0] op_sel_hi:[1,0,1]
    s_waitcnt lgkmcnt(5)
    v_pk_fma_f32 v[24:25], v[184:185], v[160:161], v[24:25] op_sel:[0,0,0] op_sel_hi:[1,0,1]
    v_pk_fma_f32 v[26:27], v[186:187], v[160:161], v[26:27] op_sel:[0,0,0] op_sel_hi:[1,0,1]
    s_waitcnt lgkmcnt(4)
    v_pk_fma_f32 v[28:29], v[188:189], v[160:161], v[28:29] op_sel:[0,0,0] op_sel_hi:[1,0,1]
    v_pk_fma_f32 v[30:31], v[190:191], v[160:161], v[30:31] op_sel:[0,0,0] op_sel_hi:[1,0,1]
    v_max_f32 v16, 0, v16
    v_max_f32 v17, 0, v17
    v_max_f32 v18, 0, v18
    v_max_f32 v19, 0, v19
    v_max_f32 v20, 0, v20
    v_max_f32 v21, 0, v21
    v_max_f32 v22, 0, v22
    v_max_f32 v23, 0, v23
    v_pk_mul_f32 v[24:25], v[24:25], v[160:161] op_sel:[0,1] op_sel_hi:[1,1]
    v_pk_mul_f32 v[26:27], v[26:27], v[160:161] op_sel:[0,1] op_sel_hi:[1,1]
    v_pk_mul_f32 v[28:29], v[28:29], v[160:161] op_sel:[0,1] op_sel_hi:[1,1]
    v_pk_mul_f32 v[30:31], v[30:31], v[160:161] op_sel:[0,1] op_sel_hi:[1,1]
    v_pk_mul_f32 v[16:17], v[16:17], v[24:25]
    v_pk_mul_f32 v[18:19], v[18:19], v[26:27]
    v_pk_mul_f32 v[20:21], v[20:21], v[28:29]
    v_pk_mul_f32 v[22:23], v[22:23], v[30:31]
    v_cvt_pk_bf16_f32 v16, v16, v17
    v_cvt_pk_bf16_f32 v17, v18, v19
    v_cvt_pk_bf16_f32 v18, v20, v21
    v_cvt_pk_bf16_f32 v19, v22, v23
    v_pk_fma_f32 v[32:33], v[176:177], v[162:163], v[32:33] op_sel:[0,0,0] op_sel_hi:[1,0,1]
    v_pk_fma_f32 v[34:35], v[178:179], v[162:163], v[34:35] op_sel:[0,0,0] op_sel_hi:[1,0,1]
    v_pk_fma_f32 v[36:37], v[180:181], v[162:163], v[36:37] op_sel:[0,0,0] op_sel_hi:[1,0,1]
    v_pk_fma_f32 v[38:39], v[182:183], v[162:163], v[38:39] op_sel:[0,0,0] op_sel_hi:[1,0,1]
    v_pk_fma_f32 v[40:41], v[184:185], v[162:163], v[40:41] op_sel:[0,0,0] op_sel_hi:[1,0,1]
    v_pk_fma_f32 v[42:43], v[186:187], v[162:163], v[42:43] op_sel:[0,0,0] op_sel_hi:[1,0,1]
    v_pk_fma_f32 v[44:45], v[188:189], v[162:163], v[44:45] op_sel:[0,0,0] op_sel_hi:[1,0,1]
    v_pk_fma_f32 v[46:47], v[190:191], v[162:163], v[46:47] op_sel:[0,0,0] op_sel_hi:[1,0,1]
    v_max_f32 v32, 0, v32
    v_max_f32 v33, 0, v33
    v_max_f32 v34, 0, v34
    v_max_f32 v35, 0, v35
    v_max_f32 v36, 0, v36
    v_max_f32 v37, 0, v37
    v_max_f32 v38, 0, v38
    v_max_f32 v39, 0, v39
    v_pk_mul_f32 v[40:41], v[40:41], v[162:163] op_sel:[0,1] op_sel_hi:[1,1]
    v_pk_mul_f32 v[42:43], v[42:43], v[162:163] op_sel:[0,1] op_sel_hi:[1,1]
    v_pk_mul_f32 v[44:45], v[44:45], v[162:163] op_sel:[0,1] op_sel_hi:[1,1]
    v_pk_mul_f32 v[46:47], v[46:47], v[162:163] op_sel:[0,1] op_sel_hi:[1,1]
    v_pk_mul_f32 v[32:33], v[32:33], v[40:41]
    v_pk_mul_f32 v[34:35], v[34:35], v[42:43]
    v_pk_mul_f32 v[36:37], v[36:37], v[44:45]
    v_pk_mul_f32 v[38:39], v[38:39], v[46:47]
    v_cvt_pk_bf16_f32 v32, v32, v33
    v_cvt_pk_bf16_f32 v33, v34, v35
    v_cvt_pk_bf16_f32 v34, v36, v37
    v_cvt_pk_bf16_f32 v35, v38, v39
    v_pk_fma_f32 v[48:49], v[176:177], v[164:165], v[48:49] op_sel:[0,0,0] op_sel_hi:[1,0,1]
    v_pk_fma_f32 v[50:51], v[178:179], v[164:165], v[50:51] op_sel:[0,0,0] op_sel_hi:[1,0,1]
    v_pk_fma_f32 v[52:53], v[180:181], v[164:165], v[52:53] op_sel:[0,0,0] op_sel_hi:[1,0,1]
    v_pk_fma_f32 v[54:55], v[182:183], v[164:165], v[54:55] op_sel:[0,0,0] op_sel_hi:[1,0,1]
    v_pk_fma_f32 v[56:57], v[184:185], v[164:165], v[56:57] op_sel:[0,0,0] op_sel_hi:[1,0,1]
    v_pk_fma_f32 v[58:59], v[186:187], v[164:165], v[58:59] op_sel:[0,0,0] op_sel_hi:[1,0,1]
    v_pk_fma_f32 v[60:61], v[188:189], v[164:165], v[60:61] op_sel:[0,0,0] op_sel_hi:[1,0,1]
    v_pk_fma_f32 v[62:63], v[190:191], v[164:165], v[62:63] op_sel:[0,0,0] op_sel_hi:[1,0,1]
    v_max_f32 v48, 0, v48
    v_max_f32 v49, 0, v49
    v_max_f32 v50, 0, v50
    v_max_f32 v51, 0, v51
    v_max_f32 v52, 0, v52
    v_max_f32 v53, 0, v53
    v_max_f32 v54, 0, v54
    v_max_f32 v55, 0, v55
    v_pk_mul_f32 v[56:57], v[56:57], v[164:165] op_sel:[0,1] op_sel_hi:[1,1]
    v_pk_mul_f32 v[58:59], v[58:59], v[164:165] op_sel:[0,1] op_sel_hi:[1,1]
    v_pk_mul_f32 v[60:61], v[60:61], v[164:165] op_sel:[0,1] op_sel_hi:[1,1]
    v_pk_mul_f32 v[62:63], v[62:63], v[164:165] op_sel:[0,1] op_sel_hi:[1,1]
    v_pk_mul_f32 v[48:49], v[48:49], v[56:57]
    v_pk_mul_f32 v[50:51], v[50:51], v[58:59]
    v_pk_mul_f32 v[52:53], v[52:53], v[60:61]
    v_pk_mul_f32 v[54:55], v[54:55], v[62:63]
    v_cvt_pk_bf16_f32 v48, v48, v49
    v_cvt_pk_bf16_f32 v49, v50, v51
    v_cvt_pk_bf16_f32 v50, v52, v53
    v_cvt_pk_bf16_f32 v51, v54, v55
    v_pk_fma_f32 v[64:65], v[176:177], v[166:167], v[64:65] op_sel:[0,0,0] op_sel_hi:[1,0,1]
    v_pk_fma_f32 v[66:67], v[178:179], v[166:167], v[66:67] op_sel:[0,0,0] op_sel_hi:[1,0,1]
    v_pk_fma_f32 v[68:69], v[180:181], v[166:167], v[68:69] op_sel:[0,0,0] op_sel_hi:[1,0,1]
    v_pk_fma_f32 v[70:71], v[182:183], v[166:167], v[70:71] op_sel:[0,0,0] op_sel_hi:[1,0,1]
    v_pk_fma_f32 v[72:73], v[184:185], v[166:167], v[72:73] op_sel:[0,0,0] op_sel_hi:[1,0,1]
    v_pk_fma_f32 v[74:75], v[186:187], v[166:167], v[74:75] op_sel:[0,0,0] op_sel_hi:[1,0,1]
    v_pk_fma_f32 v[76:77], v[188:189], v[166:167], v[76:77] op_sel:[0,0,0] op_sel_hi:[1,0,1]
    v_pk_fma_f32 v[78:79], v[190:191], v[166:167], v[78:79] op_sel:[0,0,0] op_sel_hi:[1,0,1]
    v_max_f32 v64, 0, v64
    v_max_f32 v65, 0, v65
    v_max_f32 v66, 0, v66
    v_max_f32 v67, 0, v67
    v_max_f32 v68, 0, v68
    v_max_f32 v69, 0, v69
    v_max_f32 v70, 0, v70
    v_max_f32 v71, 0, v71
    v_pk_mul_f32 v[72:73], v[72:73], v[166:167] op_sel:[0,1] op_sel_hi:[1,1]
    v_pk_mul_f32 v[74:75], v[74:75], v[166:167] op_sel:[0,1] op_sel_hi:[1,1]
    v_pk_mul_f32 v[76:77], v[76:77], v[166:167] op_sel:[0,1] op_sel_hi:[1,1]
    v_pk_mul_f32 v[78:79], v[78:79], v[166:167] op_sel:[0,1] op_sel_hi:[1,1]
    v_pk_mul_f32 v[64:65], v[64:65], v[72:73]
    v_pk_mul_f32 v[66:67], v[66:67], v[74:75]
    v_pk_mul_f32 v[68:69], v[68:69], v[76:77]
    v_pk_mul_f32 v[70:71], v[70:71], v[78:79]
    v_cvt_pk_bf16_f32 v64, v64, v65
    v_cvt_pk_bf16_f32 v65, v66, v67
    v_cvt_pk_bf16_f32 v66, v68, v69
    v_cvt_pk_bf16_f32 v67, v70, v71
    s_lshl_b32 s54, s47, 2
    s_add_u32 s54, s54, s44
    s_cmp_ge_u32 s54, 58
    s_cbranch_scc1 A_ST3_DONE
    buffer_store_dwordx4 v[16:19], v8, s[24:27], s52 offen sc1
    buffer_store_dwordx4 v[32:35], v9, s[24:27], s52 offen sc1
    buffer_store_dwordx4 v[48:51], v8, s[24:27], s53 offen sc1
    buffer_store_dwordx4 v[64:67], v9, s[24:27], s53 offen sc1
A_ST3_DONE:
    s_waitcnt lgkmcnt(3)
    v_pk_fma_f32 v[80:81], v[192:193], v[160:161], v[80:81] op_sel:[0,0,0] op_sel_hi:[1,0,1]
    v_pk_fma_f32 v[82:83], v[194:195], v[160:161], v[82:83] op_sel:[0,0,0] op_sel_hi:[1,0,1]
    s_waitcnt lgkmcnt(2)
    v_pk_fma_f32 v[84:85], v[196:197], v[160:161], v[84:85] op_sel:[0,0,0] op_sel_hi:[1,0,1]
    v_pk_fma_f32 v[86:87], v[198:199], v[160:161], v[86:87] op_sel:[0,0,0] op_sel_hi:[1,0,1]
    s_waitcnt lgkmcnt(1)
    v_pk_fma_f32 v[88:89], v[200:201], v[160:161], v[88:89] op_sel:[0,0,0] op_sel_hi:[1,0,1]
    v_pk_fma_f32 v[90:91], v[202:203], v[160:161], v[90:91] op_sel:[0,0,0] op_sel_hi:[1,0,1]
    s_waitcnt lgkmcnt(0)
    v_pk_fma_f32 v[92:93], v[204:205], v[160:161], v[92:93] op_sel:[0,0,0] op_sel_hi:[1,0,1]
    v_pk_fma_f32 v[94:95], v[206:207], v[160:161], v[94:95] op_sel:[0,0,0] op_sel_hi:[1,0,1]
    v_max_f32 v80, 0, v80
    v_max_f32 v81, 0, v81
    v_max_f32 v82, 0, v82
    v_max_f32 v83, 0, v83
    v_max_f32 v84, 0, v84
    v_max_f32 v85, 0, v85
    v_max_f32 v86, 0, v86
    v_max_f32 v87, 0, v87
    v_pk_mul_f32 v[88:89], v[88:89], v[160:161] op_sel:[0,1] op_sel_hi:[1,1]
    v_pk_mul_f32 v[90:91], v[90:91], v[160:161] op_sel:[0,1] op_sel_hi:[1,1]
    v_pk_mul_f32 v[92:93], v[92:93], v[160:161] op_sel:[0,1] op_sel_hi:[1,1]
    v_pk_mul_f32 v[94:95], v[94:95], v[160:161] op_sel:[0,1] op_sel_hi:[1,1]
    v_pk_mul_f32 v[80:81], v[80:81], v[88:89]
    v_pk_mul_f32 v[82:83], v[82:83], v[90:91]
    v_pk_mul_f32 v[84:85], v[84:85], v[92:93]
    v_pk_mul_f32 v[86:87], v[86:87], v[94:95]
    v_cvt_pk_bf16_f32 v80, v80, v81
    v_cvt_pk_bf16_f32 v81, v82, v83
    v_cvt_pk_bf16_f32 v82, v84, v85
    v_cvt_pk_bf16_f32 v83, v86, v87
    v_pk_fma_f32 v[96:97], v[192:193], v[162:163], v[96:97] op_sel:[0,0,0] op_sel_hi:[1,0,1]
    v_pk_fma_f32 v[98:99], v[194:195], v[162:163], v[98:99] op_sel:[0,0,0] op_sel_hi:[1,0,1]
    v_pk_fma_f32 v[100:101], v[196:197], v[162:163], v[100:101] op_sel:[0,0,0] op_sel_hi:[1,0,1]
    v_pk_fma_f32 v[102:103], v[198:199], v[162:163], v[102:103] op_sel:[0,0,0] op_sel_hi:[1,0,1]
    v_pk_fma_f32 v[104:105], v[200:201], v[162:163], v[104:105] op_sel:[0,0,0] op_sel_hi:[1,0,1]
    v_pk_fma_f32 v[106:107], v[202:203], v[162:163], v[106:107] op_sel:[0,0,0] op_sel_hi:[1,0,1]
    v_pk_fma_f32 v[108:109], v[204:205], v[162:163], v[108:109] op_sel:[0,0,0] op_sel_hi:[1,0,1]
    v_pk_fma_f32 v[110:111], v[206:207], v[162:163], v[110:111] op_sel:[0,0,0] op_sel_hi:[1,0,1]
    v_max_f32 v96, 0, v96
    v_max_f32 v97, 0, v97
    v_max_f32 v98, 0, v98
    v_max_f32 v99, 0, v99
    v_max_f32 v100, 0, v100
    v_max_f32 v101, 0, v101
    v_max_f32 v102, 0, v102
    v_max_f32 v103, 0, v103
    v_pk_mul_f32 v[104:105], v[104:105], v[162:163] op_sel:[0,1] op_sel_hi:[1,1]
    v_pk_mul_f32 v[106:107], v[106:107], v[162:163] op_sel:[0,1] op_sel_hi:[1,1]
    v_pk_mul_f32 v[108:109], v[108:109], v[162:163] op_sel:[0,1] op_sel_hi:[1,1]
    v_pk_mul_f32 v[110:111], v[110:111], v[162:163] op_sel:[0,1] op_sel_hi:[1,1]
    v_pk_mul_f32 v[96:97], v[96:97], v[104:105]
    v_pk_mul_f32 v[98:99], v[98:99], v[106:107]
    v_pk_mul_f32 v[100:101], v[100:101], v[108:109]
    v_pk_mul_f32 v[102:103], v[102:103], v[110:111]
    v_cvt_pk_bf16_f32 v96, v96, v97
    v_cvt_pk_bf16_f32 v97, v98, v99
    v_cvt_pk_bf16_f32 v98, v100, v101
    v_cvt_pk_bf16_f32 v99, v102, v103
    s_cmp_ge_u32 s47, 14
    s_cbranch_scc1 A_ST3Z_DONE
    buffer_store_dwordx4 v[80:83], v10, s[24:27], s52 offen sc1
    buffer_store_dwordx4 v[96:99], v11, s[24:27], s52 offen sc1
A_ST3Z_DONE:
    s_cmp_lg_u32 s47, 15
    s_cbranch_scc1 A_ST3P_DONE
    v_mov_b64 v[16:17], 0
    v_mov_b64 v[18:19], 0
    s_mul_i32 s50, s44, 90112
    s_add_u32 s50, s50, 354304
    buffer_store_dwordx4 v[16:19], v148, s[24:27], s50 offen offset:0 sc1
    buffer_store_dwordx4 v[16:19], v148, s[24:27], s50 offen offset:1024 sc1
A_ST3P_DONE:
    v_add_u32 v2, 2, v150
    v_mov_b32 v3, v151
    s_lshl_b32 s50, s47, 2
    s_add_u32 s50, s50, s44
    s_lshl_b32 s50, s50, 3
    s_add_u32 s50, s50, 644096
    v_mov_b32 v4, s50
    s_waitcnt vmcnt(0)
    s_mov_b64 exec, 1
    s_cmp_lg_u32 s49, 0
    s_cbranch_scc1 A_SIG2_SLOW
    buffer_store_dwordx2 v[2:3], v4, s[24:27], 0 offen
    s_branch A_SIG2_DONE
A_SIG2_SLOW:
    buffer_store_dwordx2 v[2:3], v4, s[24:27], 0 offen sc1
A_SIG2_DONE:
    s_mov_b64 exec, -1
    s_and_b32 s51, s46, 1
    s_lshl_b32 s51, s51, 1
    s_lshr_b32 s50, s44, 1
    s_add_u32 s52, s51, s50
    s_xor_b32 s51, s52, 1
    s_mul_i32 s51, s51, 90112
    s_mul_i32 s52, s52, 90112
    s_add_u32 s51, s51, 266240
    s_add_u32 s52, s52, 266240
    v_add_u32 v12, s51, v148
    v_add_u32 v13, s52, v148
    s_mul_i32 s92, s44, 24576
    s_add_u32 s92, s92, 49152
    s_barrier
    v_lshlrev_b32 v4, 3, v0
    v_add_u32 v2, 2, v150
    v_mov_b32 v3, v151
    s_mov_b32 s57, 0
    s_mov_b32 s50, 644096
POLL2:
    buffer_load_dwordx2 v[6:7], v4, s[24:27], s50 offen sc1
    s_add_u32 s57, s57, 1
    s_waitcnt vmcnt(0)
    v_cmp_ne_u64 vcc, v[6:7], v[2:3]
    s_cmp_ge_u32 s57, 20000
    s_cbranch_scc1 POLL2_DONE
    s_cbranch_vccnz POLL2
POLL2_DONE:
    s_add_u32 m0, s92, 0
    s_nop 0
    buffer_load_dwordx4 v12, s[24:27], s64 offen sc1 lds
    s_add_u32 m0, s92, 1024
    s_nop 0
    buffer_load_dwordx4 v12, s[24:27], s65 offen sc1 lds
    s_add_u32 m0, s92, 2048
    s_nop 0
    buffer_load_dwordx4 v12, s[24:27], s66 offen sc1 lds
    s_add_u32 m0, s92, 3072
    s_nop 0
    buffer_load_dwordx4 v12, s[24:27], s67 offen sc1 lds
    s_add_u32 m0, s92, 4096
    s_nop 0
    buffer_load_dwordx4 v12, s[24:27], s68 offen sc1 lds
    s_add_u32 m0, s92, 5120
    s_nop 0
    buffer_load_dwordx4 v12, s[24:27], s69 offen sc1 lds
    s_add_u32 m0, s92, 6144
    s_nop 0
    buffer_load_dwordx4 v12, s[24:27], s70 offen sc1 lds
    s_add_u32 m0, s92, 7168
    s_nop 0
    buffer_load_dwordx4 v12, s[24:27], s71 offen sc1 lds
    s_waitcnt vmcnt(4)
    s_barrier
    s_add_u32 m0, s92, 8192
    s_nop 0
    buffer_load_dwordx4 v12, s[24:27], s72 offen sc1 lds
    s_add_u32 m0, s92, 9216
    s_nop 0
    buffer_load_dwordx4 v12, s[24:27], s73 offen sc1 lds
    s_add_u32 m0, s92, 10240
    s_nop 0
    buffer_load_dwordx4 v12, s[24:27], s74 offen sc1 lds
    s_add_u32 m0, s92, 11264
    s_nop 0
    buffer_load_dwordx4 v12, s[24:27], s75 offen sc1 lds
    s_add_u32 m0, s92, 12288
    s_nop 0
    buffer_load_dwordx4 v12, s[24:27], s76 offen sc1 lds
    s_add_u32 m0, s92, 13312
    s_nop 0
    buffer_load_dwordx4 v12, s[24:27], s77 offen sc1 lds
    s_add_u32 m0, s92, 14336
    s_nop 0
    buffer_load_dwordx4 v12, s[24:27], s78 offen sc1 lds
    s_add_u32 m0, s92, 15360
    s_nop 0
    buffer_load_dwordx4 v12, s[24:27], s79 offen sc1 lds
    s_waitcnt vmcnt(8)
    s_barrier
    s_add_u32 m0, s92, 16384
    s_nop 0
    buffer_load_dwordx4 v12, s[24:27], s80 offen sc1 lds
    s_add_u32 m0, s92, 17408
    s_nop 0
    buffer_load_dwordx4 v12, s[24:27], s81 offen sc1 lds
    s_add_u32 m0, s92, 18432
    s_nop 0
    buffer_load_dwordx4 v12, s[24:27], s82 offen sc1 lds
    s_add_u32 m0, s92, 19456
    s_nop 0
    buffer_load_dwordx4 v12, s[24:27], s83 offen sc1 lds
    s_add_u32 m0, s92, 20480
    s_nop 0
    buffer_load_dwordx4 v12, s[24:27], s84 offen sc1 lds
    s_add_u32 m0, s92, 21504
    s_nop 0
    buffer_load_dwordx4 v12, s[24:27], s85 offen sc1 lds
    s_add_u32 m0, s92, 22528
    s_nop 0
    buffer_load_dwordx4 v13, s[24:27], s64 offen sc1 lds
    s_add_u32 m0, s92, 23552
    s_nop 0
    buffer_load_dwordx4 v13, s[24:27], s65 offen sc1 lds
    s_waitcnt vmcnt(12)
    s_barrier
    s_add_u32 m0, s92, 0
    s_nop 0
    buffer_load_dwordx4 v13, s[24:27], s66 offen sc1 lds
    s_add_u32 m0, s92, 1024
    s_nop 0
    buffer_load_dwordx4 v13, s[24:27], s67 offen sc1 lds
    s_add_u32 m0, s92, 2048
    s_nop 0
    buffer_load_dwordx4 v13, s[24:27], s68 offen sc1 lds
    s_add_u32 m0, s92, 3072
    s_nop 0
    buffer_load_dwordx4 v13, s[24:27], s69 offen sc1 lds
    s_waitcnt vmcnt(12)
    s_barrier
    s_add_u32 m0, s92, 4096
    s_nop 0
    buffer_load_dwordx4 v13, s[24:27], s70 offen sc1 lds
    s_add_u32 m0, s92, 5120
    s_nop 0
    buffer_load_dwordx4 v13, s[24:27], s71 offen sc1 lds
    s_add_u32 m0, s92, 6144
    s_nop 0
    buffer_load_dwordx4 v13, s[24:27], s72 offen sc1 lds
    s_add_u32 m0, s92, 7168
    s_nop 0
    buffer_load_dwordx4 v13, s[24:27], s73 offen sc1 lds
    s_waitcnt vmcnt(12)
    s_barrier
    s_add_u32 m0, s92, 8192
    s_nop 0
    buffer_load_dwordx4 v13, s[24:27], s74 offen sc1 lds
    s_add_u32 m0, s92, 9216
    s_nop 0
    buffer_load_dwordx4 v13, s[24:27], s75 offen sc1 lds
    s_add_u32 m0, s92, 10240
    s_nop 0
    buffer_load_dwordx4 v13, s[24:27], s76 offen sc1 lds
    s_add_u32 m0, s92, 11264
    s_nop 0
    buffer_load_dwordx4 v13, s[24:27], s77 offen sc1 lds
    s_waitcnt vmcnt(12)
    s_barrier
    s_add_u32 m0, s92, 12288
    s_nop 0
    buffer_load_dwordx4 v13, s[24:27], s78 offen sc1 lds
    s_add_u32 m0, s92, 13312
    s_nop 0
    buffer_load_dwordx4 v13, s[24:27], s79 offen sc1 lds
    s_add_u32 m0, s92, 14336
    s_nop 0
    buffer_load_dwordx4 v13, s[24:27], s80 offen sc1 lds
    s_add_u32 m0, s92, 15360
    s_nop 0
    buffer_load_dwordx4 v13, s[24:27], s81 offen sc1 lds
    s_waitcnt vmcnt(12)
    s_barrier
    s_add_u32 m0, s92, 16384
    s_nop 0
    buffer_load_dwordx4 v13, s[24:27], s82 offen sc1 lds
    s_add_u32 m0, s92, 17408
    s_nop 0
    buffer_load_dwordx4 v13, s[24:27], s83 offen sc1 lds
    s_add_u32 m0, s92, 18432
    s_nop 0
    buffer_load_dwordx4 v13, s[24:27], s84 offen sc1 lds
    s_add_u32 m0, s92, 19456
    s_nop 0
    buffer_load_dwordx4 v13, s[24:27], s85 offen sc1 lds
    s_waitcnt vmcnt(12)
    s_barrier
    s_waitcnt vmcnt(8)
    s_barrier
    s_waitcnt vmcnt(4)
    s_barrier
    s_waitcnt vmcnt(0)
    s_barrier
K_END:
    s_endpgm
.section .rodata,"a"
.p2align 6
.amdhsa_kernel sequential_preLN__sliding_local_dilated__glu_gated_reglu__prompt_kernel
  .amdhsa_next_free_vgpr 256
  .amdhsa_next_free_sgpr 102
  .amdhsa_accum_offset 256
  .amdhsa_group_segment_fixed_size 0
  .amdhsa_kernarg_size 80
  .amdhsa_user_sgpr_count 2
  .amdhsa_user_sgpr_kernarg_segment_ptr 1
  .amdhsa_system_sgpr_workgroup_id_x 1
.end_amdhsa_kernel
```
